```python
import torch

def _softmax(x, axis=-1):
    return torch.softmax(x, dim=axis)
def _gelu(x):
    return torch.nn.functional.gelu(x, approximate="tanh")
def _silu(x):
    return torch.nn.functional.silu(x)
def _sigmoid(x):
    return torch.sigmoid(x)
def _layernorm(x, axis=-1, eps=1e-5):
    m = x.mean(dim=axis, keepdim=True)
    v = x.var(dim=axis, keepdim=True, unbiased=False)
    return (x - m) / torch.sqrt(v + eps)
def _scatter_add(tgt, idx, src, axis=0):
    return tgt.clone().index_add_(axis, idx, src)
def _segment_sum(src, seg, n):
    out = torch.zeros((n,) + src.shape[1:], dtype=src.dtype)
    return out.index_add_(0, seg, src)
def _pad(x, pw):
    flat = tuple(v for pair in reversed(pw) for v in pair)
    return torch.nn.functional.pad(x, flat)

kernel_name = 'parallel_sum__linear_kernel_hedgehog__glu_gated_reglu__prompt'

def setup_inputs():

    _w = (lambda a: (lambda t: t.to(torch.bfloat16) if t.is_floating_point() else t)(torch.as_tensor(a)))
    def _A_setup():
        B, S, D, H = 1, 2048, 640, 32
        Dh = D // H
        return {
            "x": _w((lambda *s: torch.randn(*s, dtype=torch.bfloat16) * 0.05)(B, S, D)),
            "wqkv": _w((lambda *s: torch.randn(*s, dtype=torch.bfloat16) * 0.2)(D, 3 * D)),
            "w_phi": _w((lambda *s: torch.randn(*s, dtype=torch.bfloat16) * 0.2)(H, Dh, Dh) * (Dh ** -0.5)),
            "wo": _w((lambda *s: torch.randn(*s, dtype=torch.bfloat16) * 0.05)(D, D)),
        }
    _A_in = _A_setup()

    def _B_setup():
        B, S, D, F = 1, 2048, 640, 1536
        return {
            "x": _w((lambda *s: torch.randn(*s, dtype=torch.bfloat16) * 0.05)(B, S, D)),
            "W_gate": _w((lambda *s: torch.randn(*s, dtype=torch.bfloat16) * 0.4)(D, F) * (2.0 / D) ** 0.5),
            "W_up": _w((lambda *s: torch.randn(*s, dtype=torch.bfloat16) * 0.4)(D, F) * (2.0 / D) ** 0.5),
            "W_down": _w((lambda *s: torch.randn(*s, dtype=torch.bfloat16) * 0.4)(F, D) * (1.0 / F) ** 0.5),
        }
    _B_in = _B_setup()

    return {
        "A_x": _A_in["x"],
        "A_wqkv": _A_in["wqkv"],
        "A_w_phi": _A_in["w_phi"],
        "A_wo": _A_in["wo"],
        "B_x": _B_in["x"],
        "B_W_gate": _B_in["W_gate"],
        "B_W_up": _B_in["W_up"],
        "B_W_down": _B_in["W_down"],
    }

def reference(A_x, A_wqkv, A_w_phi, A_wo, B_x, B_W_gate, B_W_up, B_W_down):
    def _A_ref(x, wqkv, w_phi, wo):
        B, S, D = x.shape
        H = 32; Dh = D // H
        qkv = (lambda x, *d: x.permute(*d))((x @ wqkv).reshape(B, S, 3, H, Dh), 2, 0, 3, 1, 4)
        q, k, v = qkv[0], qkv[1], qkv[2]
        pq = torch.einsum("bhsd,hdf->bhsf", q, w_phi)
        pk = torch.einsum("bhsd,hdf->bhsf", k, w_phi)
        phi_q = torch.concatenate([_softmax(pq, axis=-1), _softmax(-pq, axis=-1)], axis=-1)
        phi_k = torch.concatenate([_softmax(pk, axis=-1), _softmax(-pk, axis=-1)], axis=-1)
        kv = torch.einsum("bhsf,bhsd->bhfd", phi_k, v)
        z  = torch.einsum("bhsf->bhf", phi_k)
        num = torch.einsum("bhqf,bhfd->bhqd", phi_q, kv)
        den = torch.einsum("bhqf,bhf->bhq", phi_q, z)[..., None] + 1e-6
        o = num / den
        return (lambda x, *d: x.permute(*d))(o, 0, 2, 1, 3).reshape(B, S, D) @ wo

    def _B_ref(x, W_gate, W_up, W_down):
        gate = torch.einsum("bsd,df->bsf", x, W_gate)
        up = torch.einsum("bsd,df->bsf", x, W_up)
        gate = gate * (lambda x, dt: x.to(dt))(gate > 0, gate.dtype)
        h = gate * up
        return torch.einsum("bsf,fd->bsd", h, W_down)

    x = A_x
    xn = _layernorm(x, axis=-1)
    return x + _A_ref(xn, A_wqkv, A_w_phi, A_wo) + _B_ref(xn, B_W_gate, B_W_up, B_W_down)
```

```asm
; @launch grid=(256,1,1) block=(256,1,1) lds=163840
.amdgcn_target "amdgcn-amd-amdhsa--gfx950"
.text
.globl parallel_sum__linear_kernel_hedgehog__glu_gated_reglu__prompt_kernel
.p2align 8
.type parallel_sum__linear_kernel_hedgehog__glu_gated_reglu__prompt_kernel,@function
parallel_sum__linear_kernel_hedgehog__glu_gated_reglu__prompt_kernel:
    s_cmp_ge_u32 s2, 256
    s_cbranch_scc1 L_end
    s_getpc_b64 s[86:87]
L_pc:
    s_load_dwordx2 s[4:5], s[0:1], 0
    s_load_dwordx2 s[28:29], s[0:1], 80
    s_load_dwordx2 s[8:9], s[0:1], 8
    s_load_dwordx2 s[12:13], s[0:1], 40
    s_load_dwordx2 s[16:17], s[0:1], 48
    s_load_dwordx2 s[20:21], s[0:1], 56
    s_load_dwordx2 s[24:25], s[0:1], 24
    s_load_dwordx2 s[32:33], s[0:1], 64
    s_load_dwordx2 s[36:37], s[0:1], 16
    v_and_b32 v1, 63, v0
    v_lshrrev_b32 v20, 6, v0
    v_lshlrev_b32 v2, 4, v1
    v_readfirstlane_b32 s3, v20
    s_lshr_b32 s52, s2, 3
    s_lshl_b32 s52, s52, 2
    s_add_u32 s52, s52, s3
    s_lshl_b32 s52, s52, 8
    v_and_b32 v21, 1, v0
    v_lshlrev_b32 v21, 7, v21
    v_add_u32 v21, s52, v21
    v_min_u32 v21, L_code_end-L_pc-4, v21
    s_and_b32 s50, s2, 7
    s_lshr_b32 s51, s2, 3
    s_lshr_b32 s46, s50, 2
    s_lshl_b32 s46, s46, 3
    s_lshr_b32 s52, s51, 2
    s_add_u32 s46, s46, s52
    s_add_u32 s47, s50, 0
    s_and_b32 s47, s47, 3
    s_lshl_b32 s47, s47, 2
    s_and_b32 s52, s51, 3
    s_add_u32 s47, s47, s52
    s_lshl_b32 s48, s50, 2
    s_lshr_b32 s52, s51, 3
    s_add_u32 s48, s48, s52
    s_and_b32 s49, s51, 7
    v_and_b32 v20, 7, v1
    v_lshrrev_b32 v21, 3, v1
    s_lshl_b32 s50, s46, 4
    s_add_u32 s50, s50, s47
    s_mul_i32 s50, s50, 10240
    v_mul_u32_u24 v22, 1280, v20
    v_add_u32 v22, s50, v22
    v_lshl_add_u32 v23, v21, 4, v22
    s_lshl_b32 s51, s3, 7
    s_mov_b32 s6, 2621440
    s_mov_b32 s7, 0x20000
    s_mov_b32 s30, 25165824
    s_mov_b32 s31, 0x20000
    s_mov_b32 s10, 2457600
    s_mov_b32 s11, 0x20000
    s_mov_b32 s14, 1966080
    s_mov_b32 s15, 0x20000
    s_mov_b32 s18, 1966080
    s_mov_b32 s19, 0x20000
    s_mov_b32 s22, 1966080
    s_mov_b32 s23, 0x20000
    s_mov_b32 s26, 819200
    s_mov_b32 s27, 0x20000
    s_mov_b32 s34, 2621440
    s_mov_b32 s35, 0x20000
    s_mov_b32 s38, 25600
    s_mov_b32 s39, 0x20000
    v_mov_b32 v3, 1073741824
    v_cmp_eq_u32 vcc, 0, v1
    v_mov_b32 v24, 0
    s_nop 0
    v_cndmask_b32 v3, v3, v24, vcc
    s_waitcnt lgkmcnt(0)
    buffer_load_ushort v36, v22, s[4:7], 0 offen
    buffer_load_dwordx4 v[24:27], v23, s[4:7], s51 offen offset:0
    buffer_load_dwordx4 v[28:31], v23, s[4:7], s51 offen offset:512
    s_cmp_ge_u32 s3, 2
    s_cbranch_scc1 L_ln3_1
    buffer_load_dwordx4 v[32:35], v23, s[4:7], s51 offen offset:1024
L_ln3_1:
    s_lshr_b32 s52, s2, 3
    s_lshl_b32 s52, s52, 2
    s_add_u32 s52, s52, s3
    s_lshl_b32 s52, s52, 8
    v_and_b32 v21, 1, v1
    v_lshlrev_b32 v21, 7, v21
    v_add_u32 v21, s52, v21
    v_min_u32 v21, L_code_end-L_pc-4, v21
    global_load_dword v83, v21, s[86:87]
    buffer_load_dwordx2 v[4:5], v3, s[28:31], 0 offen sc1
    s_add_u32 s50, s46, s47
    s_and_b32 s50, s50, 3
    s_add_u32 s51, s48, s49
    s_and_b32 s51, s51, 0
    v_mov_b32 v82, 0
    v_lshrrev_b32 v40, 4, v1
    v_and_b32 v41, 15, v1
    v_mul_u32_u24 v42, 13, v41
    v_lshrrev_b32 v42, 6, v42
    v_mul_u32_u24 v43, 5, v42
    v_sub_u32 v43, v41, v43
    v_add_u32 v44, 1, v42
    v_mul_u32_u24 v44, 1280, v44
    v_cmp_eq_u32 vcc, 2, v42
    v_mov_b32 v45, 0
    s_nop 0
    v_cndmask_b32 v44, v44, v45, vcc
    v_cmp_eq_u32 vcc, 3, v42
    v_mov_b32 v45, 1073741824
    s_nop 0
    v_cndmask_b32 v44, v44, v45, vcc
    v_lshl_add_u32 v44, v43, 4, v44
    v_mul_u32_u24 v40, 3840, v40
    v_add_u32 v82, v40, v44
    s_cmp_lt_u32 s2, 160
    s_cselect_b32 s55, 0, 536870912
    v_add_u32 v82, s55, v82
    s_and_b32 s52, s2, 7
    s_mul_i32 s52, s52, 5
    s_lshr_b32 s53, s2, 5
    s_add_u32 s52, s52, s53
    s_lshr_b32 s53, s2, 3
    s_and_b32 s53, s53, 3
    s_lshl_b32 s53, s53, 2
    s_add_u32 s53, s53, s3
    s_mul_i32 s52, s52, 61440
    s_mul_i32 s53, s53, 80
    s_add_u32 s52, s52, s53
    s_lshl_b32 s54, s3, 12
    s_add_u32 s54, s54, 139264
    s_mov_b32 s72, s52
    s_mov_b32 s73, s54
    s_mov_b32 m0, s73
    s_add_u32 s73, s73, 1024
    buffer_load_dwordx4 v82, s[8:11], s72 offen lds
    s_add_u32 s72, s72, 15360
    s_mov_b32 m0, s73
    s_add_u32 s73, s73, 1024
    buffer_load_dwordx4 v82, s[8:11], s72 offen lds
    s_add_u32 s72, s72, 15360
    s_mov_b32 m0, s73
    s_add_u32 s73, s73, 1024
    buffer_load_dwordx4 v82, s[8:11], s72 offen lds
    s_add_u32 s72, s72, 15360
    s_mov_b32 m0, s73
    s_add_u32 s73, s73, 1024
    buffer_load_dwordx4 v82, s[8:11], s72 offen lds
    s_add_u32 s72, s72, 15360
    s_mul_i32 s52, s47, 192
    s_bitcmp1_b32 s47, 0
    s_cselect_b32 s53, 0, 128
    s_add_u32 s68, s52, s53
    s_bitcmp1_b32 s47, 0
    s_cselect_b32 s53, 64, 0
    s_add_u32 s69, s52, s53
    s_lshl_b32 s52, s46, 1
    s_lshr_b32 s53, s3, 1
    s_add_u32 s52, s52, s53
    s_mul_i32 s52, s52, 278528
    s_and_b32 s53, s3, 1
    s_lshl_b32 s53, s53, 11
    s_add_u32 s52, s52, s53
    s_add_u32 s80, s52, 10485760
    s_lshl_b32 s53, s68, 6
    s_add_u32 s70, s80, s53
    s_lshl_b32 s53, s69, 6
    s_add_u32 s71, s80, s53
    v_lshrrev_b32 v100, 2, v1
    v_mul_u32_u24 v100, 3072, v100
    v_and_b32 v101, 3, v1
    v_lshl_add_u32 v100, v101, 4, v100
    v_add_u32 v6, s68, v100
    v_lshrrev_b32 v100, 3, v1
    v_bfe_u32 v102, v1, 2, 1
    v_bfe_u32 v103, v1, 4, 1
    v_xor_b32 v102, v102, v103
    v_mul_u32_u24 v100, 3072, v100
    v_lshl_add_u32 v100, v102, 6, v100
    v_lshl_add_u32 v100, v101, 4, v100
    v_add_u32 v7, s69, v100
    v_lshrrev_b32 v100, 5, v1
    v_bfe_u32 v101, v1, 2, 2
    v_lshl_add_u32 v102, v100, 3, v101
    v_bfe_u32 v103, v1, 4, 1
    v_and_b32 v104, 3, v1
    v_lshlrev_b32 v105, 5, v103
    v_lshl_add_u32 v105, v104, 3, v105
    v_lshl_add_u32 v8, v102, 6, v105
    v_lshl_add_u32 v106, v102, 7, v105
    v_bfe_u32 v107, v1, 3, 1
    v_lshl_add_u32 v9, v107, 6, v106
    v_xor_b32 v10, 64, v9
    s_lshr_b32 s52, s3, 1
    s_and_b32 s53, s3, 1
    s_mul_i32 s54, s52, 80
    s_lshl_b32 s53, s53, 6
    s_add_u32 s54, s54, s53
    s_add_u32 s54, s54, 122880
    v_mul_u32_u24 v106, 176, v102
    v_add3_u32 v20, v106, v105, s54
    s_mul_i32 s54, s52, 48
    s_add_u32 s54, s54, 145408
    v_mul_u32_u24 v106, 104, v102
    v_add3_u32 v21, v106, v105, s54
    v_and_b32 v100, 31, v1
    v_lshrrev_b32 v101, 5, v1
    s_lshl_b32 s52, s3, 5
    v_add_u32 v102, s52, v100
    v_mul_u32_u24 v103, 176, v102
    v_mul_u32_u24 v104, 80, v101
    v_add_u32 v103, v103, v104
    v_add_u32 v18, 122880, v103
    v_mul_u32_u24 v103, 104, v102
    v_mul_u32_u24 v104, 48, v101
    v_add_u32 v103, v103, v104
    v_add_u32 v19, 145408, v103
    v_lshrrev_b32 v103, 4, v100
    v_lshlrev_b32 v103, 10, v103
    v_lshl_add_u32 v103, v101, 8, v103
    v_and_b32 v104, 15, v100
    v_lshl_add_u32 v13, v104, 4, v103
    s_cmp_lg_u32 s3, 0
    s_cbranch_scc1 L_wphi_2
    s_mul_i32 s52, s47, 1600
    s_mov_b32 m0, 160000
    v_add_u32 v81, 1024, v2
    buffer_load_dwordx4 v2, s[36:39], s52 offen lds
    v_cmp_gt_u32 vcc, 36, v1
    s_nop 0
    s_and_saveexec_b64 s[54:55], vcc
    s_mov_b32 m0, 161024
    s_nop 0
    buffer_load_dwordx4 v81, s[36:39], s52 offen lds
    s_mov_b64 exec, s[54:55]
L_wphi_2:
    v_mov_b32 v76, 0
    v_mov_b32 v77, 0
    v_mov_b32 v78, 0
    v_mov_b32 v79, 0
    v_add_u32 v80, 162880, v2
    v_min_u32 v80, 163824, v80
    ds_write_b128 v80, v[76:79]
    s_waitcnt vmcnt(6)
    v_lshlrev_b32 v37, 16, v36
    v_mov_b32 v76, 0
    v_mov_b32 v77, 0
    v_mov_b32 v78, 0
    v_mov_b32 v79, 0
    v_lshlrev_b32 v40, 16, v24
    v_and_b32 v41, 0xffff0000, v24
    v_pk_add_f32 v[40:41], v[40:41], v[36:37] op_sel:[0,1] op_sel_hi:[1,1] neg_lo:[0,1] neg_hi:[0,1]
    v_pk_add_f32 v[76:77], v[76:77], v[40:41]
    v_pk_fma_f32 v[78:79], v[40:41], v[40:41], v[78:79]
    v_lshlrev_b32 v42, 16, v25
    v_and_b32 v43, 0xffff0000, v25
    v_pk_add_f32 v[42:43], v[42:43], v[36:37] op_sel:[0,1] op_sel_hi:[1,1] neg_lo:[0,1] neg_hi:[0,1]
    v_pk_add_f32 v[76:77], v[76:77], v[42:43]
    v_pk_fma_f32 v[78:79], v[42:43], v[42:43], v[78:79]
    v_lshlrev_b32 v44, 16, v26
    v_and_b32 v45, 0xffff0000, v26
    v_pk_add_f32 v[44:45], v[44:45], v[36:37] op_sel:[0,1] op_sel_hi:[1,1] neg_lo:[0,1] neg_hi:[0,1]
    v_pk_add_f32 v[76:77], v[76:77], v[44:45]
    v_pk_fma_f32 v[78:79], v[44:45], v[44:45], v[78:79]
    v_lshlrev_b32 v46, 16, v27
    v_and_b32 v47, 0xffff0000, v27
    v_pk_add_f32 v[46:47], v[46:47], v[36:37] op_sel:[0,1] op_sel_hi:[1,1] neg_lo:[0,1] neg_hi:[0,1]
    v_pk_add_f32 v[76:77], v[76:77], v[46:47]
    v_pk_fma_f32 v[78:79], v[46:47], v[46:47], v[78:79]
    v_lshlrev_b32 v48, 16, v28
    v_and_b32 v49, 0xffff0000, v28
    v_pk_add_f32 v[48:49], v[48:49], v[36:37] op_sel:[0,1] op_sel_hi:[1,1] neg_lo:[0,1] neg_hi:[0,1]
    v_pk_add_f32 v[76:77], v[76:77], v[48:49]
    v_pk_fma_f32 v[78:79], v[48:49], v[48:49], v[78:79]
    v_lshlrev_b32 v50, 16, v29
    v_and_b32 v51, 0xffff0000, v29
    v_pk_add_f32 v[50:51], v[50:51], v[36:37] op_sel:[0,1] op_sel_hi:[1,1] neg_lo:[0,1] neg_hi:[0,1]
    v_pk_add_f32 v[76:77], v[76:77], v[50:51]
    v_pk_fma_f32 v[78:79], v[50:51], v[50:51], v[78:79]
    v_lshlrev_b32 v52, 16, v30
    v_and_b32 v53, 0xffff0000, v30
    v_pk_add_f32 v[52:53], v[52:53], v[36:37] op_sel:[0,1] op_sel_hi:[1,1] neg_lo:[0,1] neg_hi:[0,1]
    v_pk_add_f32 v[76:77], v[76:77], v[52:53]
    v_pk_fma_f32 v[78:79], v[52:53], v[52:53], v[78:79]
    v_lshlrev_b32 v54, 16, v31
    v_and_b32 v55, 0xffff0000, v31
    v_pk_add_f32 v[54:55], v[54:55], v[36:37] op_sel:[0,1] op_sel_hi:[1,1] neg_lo:[0,1] neg_hi:[0,1]
    v_pk_add_f32 v[76:77], v[76:77], v[54:55]
    v_pk_fma_f32 v[78:79], v[54:55], v[54:55], v[78:79]
    s_cmp_ge_u32 s3, 2
    s_cbranch_scc1 L_lns_3
    v_lshlrev_b32 v56, 16, v32
    v_and_b32 v57, 0xffff0000, v32
    v_pk_add_f32 v[56:57], v[56:57], v[36:37] op_sel:[0,1] op_sel_hi:[1,1] neg_lo:[0,1] neg_hi:[0,1]
    v_pk_add_f32 v[76:77], v[76:77], v[56:57]
    v_pk_fma_f32 v[78:79], v[56:57], v[56:57], v[78:79]
    v_lshlrev_b32 v58, 16, v33
    v_and_b32 v59, 0xffff0000, v33
    v_pk_add_f32 v[58:59], v[58:59], v[36:37] op_sel:[0,1] op_sel_hi:[1,1] neg_lo:[0,1] neg_hi:[0,1]
    v_pk_add_f32 v[76:77], v[76:77], v[58:59]
    v_pk_fma_f32 v[78:79], v[58:59], v[58:59], v[78:79]
    v_lshlrev_b32 v60, 16, v34
    v_and_b32 v61, 0xffff0000, v34
    v_pk_add_f32 v[60:61], v[60:61], v[36:37] op_sel:[0,1] op_sel_hi:[1,1] neg_lo:[0,1] neg_hi:[0,1]
    v_pk_add_f32 v[76:77], v[76:77], v[60:61]
    v_pk_fma_f32 v[78:79], v[60:61], v[60:61], v[78:79]
    v_lshlrev_b32 v62, 16, v35
    v_and_b32 v63, 0xffff0000, v35
    v_pk_add_f32 v[62:63], v[62:63], v[36:37] op_sel:[0,1] op_sel_hi:[1,1] neg_lo:[0,1] neg_hi:[0,1]
    v_pk_add_f32 v[76:77], v[76:77], v[62:63]
    v_pk_fma_f32 v[78:79], v[62:63], v[62:63], v[78:79]
L_lns_3:
    v_add_f32 v38, v76, v77
    v_add_f32 v39, v78, v79
    s_nop 0
    v_add_f32_dpp v38, v38, v38 row_ror:8 row_mask:0xf bank_mask:0xf
    v_add_f32_dpp v39, v39, v39 row_ror:8 row_mask:0xf bank_mask:0xf
    v_mov_b32 v64, v38
    v_mov_b32 v65, v39
    s_nop 0
    v_permlane16_swap_b32 v38, v64
    v_permlane16_swap_b32 v39, v65
    v_add_f32 v38, v38, v64
    v_add_f32 v39, v39, v65
    v_mov_b32 v64, v38
    v_mov_b32 v65, v39
    s_nop 0
    v_permlane32_swap_b32 v38, v64
    v_permlane32_swap_b32 v39, v65
    v_add_f32 v38, v38, v64
    v_add_f32 v39, v39, v65
    v_and_b32 v66, 7, v1
    v_lshlrev_b32 v66, 5, v66
    v_add_u32 v66, 159744, v66
    s_lshl_b32 s52, s3, 3
    v_add_u32 v67, s52, v66
    ds_write_b64 v67, v[38:39]
    s_waitcnt lgkmcnt(0)
    s_barrier
    ds_read_b128 v[68:71], v66
    ds_read_b128 v[72:75], v66 offset:16
    s_waitcnt lgkmcnt(1)
    v_add_f32 v68, v68, v70
    v_add_f32 v69, v69, v71
    s_waitcnt lgkmcnt(0)
    v_add_f32 v72, v72, v74
    v_add_f32 v73, v73, v75
    v_add_f32 v68, v68, v72
    v_add_f32 v69, v69, v73
    v_mul_f32 v68, 0x3acccccd, v68
    v_mul_f32 v69, 0x3acccccd, v69
    v_fma_f32 v69, -v68, v68, v69
    v_max_f32 v69, 0, v69
    v_add_f32 v69, 0x3727c5ac, v69
    v_rsq_f32 v69, v69
    s_nop 0
    v_mul_f32 v68, v68, v69
    v_sub_f32 v68, 0, v68
    v_lshrrev_b32 v70, 3, v1
    v_lshlrev_b32 v70, 9, v70
    v_and_b32 v71, 7, v1
    v_lshl_add_u32 v70, v71, 4, v70
    s_lshl_b32 s52, s46, 2
    s_lshr_b32 s53, s47, 2
    s_add_u32 s52, s52, s53
    s_mul_i32 s52, s52, 40960
    s_and_b32 s53, s47, 3
    s_lshl_b32 s53, s53, 7
    s_add_u32 s52, s52, s53
    s_lshl_b32 s53, s3, 12
    s_add_u32 s52, s52, s53
    s_add_u32 s52, s52, 1048576
    v_pk_fma_f32 v[40:41], v[40:41], v[68:69], v[68:69] op_sel:[0,1,0] op_sel_hi:[1,1,0]
    v_cvt_pk_bf16_f32 v24, v40, v41
    v_pk_fma_f32 v[42:43], v[42:43], v[68:69], v[68:69] op_sel:[0,1,0] op_sel_hi:[1,1,0]
    v_cvt_pk_bf16_f32 v25, v42, v43
    v_pk_fma_f32 v[44:45], v[44:45], v[68:69], v[68:69] op_sel:[0,1,0] op_sel_hi:[1,1,0]
    v_cvt_pk_bf16_f32 v26, v44, v45
    v_pk_fma_f32 v[46:47], v[46:47], v[68:69], v[68:69] op_sel:[0,1,0] op_sel_hi:[1,1,0]
    v_cvt_pk_bf16_f32 v27, v46, v47
    buffer_store_dwordx4 v[24:27], v70, s[28:31], s52 offen sc1
    s_add_u32 s52, s52, 16384
    v_pk_fma_f32 v[48:49], v[48:49], v[68:69], v[68:69] op_sel:[0,1,0] op_sel_hi:[1,1,0]
    v_cvt_pk_bf16_f32 v28, v48, v49
    v_pk_fma_f32 v[50:51], v[50:51], v[68:69], v[68:69] op_sel:[0,1,0] op_sel_hi:[1,1,0]
    v_cvt_pk_bf16_f32 v29, v50, v51
    v_pk_fma_f32 v[52:53], v[52:53], v[68:69], v[68:69] op_sel:[0,1,0] op_sel_hi:[1,1,0]
    v_cvt_pk_bf16_f32 v30, v52, v53
    v_pk_fma_f32 v[54:55], v[54:55], v[68:69], v[68:69] op_sel:[0,1,0] op_sel_hi:[1,1,0]
    v_cvt_pk_bf16_f32 v31, v54, v55
    buffer_store_dwordx4 v[28:31], v70, s[28:31], s52 offen sc1
    s_cmp_ge_u32 s3, 2
    s_cbranch_scc1 L_lnn_4
    s_add_u32 s52, s52, 16384
    v_pk_fma_f32 v[56:57], v[56:57], v[68:69], v[68:69] op_sel:[0,1,0] op_sel_hi:[1,1,0]
    v_cvt_pk_bf16_f32 v32, v56, v57
    v_pk_fma_f32 v[58:59], v[58:59], v[68:69], v[68:69] op_sel:[0,1,0] op_sel_hi:[1,1,0]
    v_cvt_pk_bf16_f32 v33, v58, v59
    v_pk_fma_f32 v[60:61], v[60:61], v[68:69], v[68:69] op_sel:[0,1,0] op_sel_hi:[1,1,0]
    v_cvt_pk_bf16_f32 v34, v60, v61
    v_pk_fma_f32 v[62:63], v[62:63], v[68:69], v[68:69] op_sel:[0,1,0] op_sel_hi:[1,1,0]
    v_cvt_pk_bf16_f32 v35, v62, v63
    buffer_store_dwordx4 v[32:35], v70, s[28:31], s52 offen sc1
L_lnn_4:
    v_lshrrev_b32 v40, 4, v1
    v_and_b32 v41, 15, v1
    v_lshrrev_b32 v42, 2, v41
    v_and_b32 v43, 3, v41
    v_lshrrev_b32 v44, 1, v40
    v_lshl_add_u32 v42, v44, 3, v42
    v_lshlrev_b32 v42, 8, v42
    s_lshl_b32 s52, s3, 12
    s_add_u32 s52, s52, 139264
    v_add_u32 v42, s52, v42
    v_and_b32 v40, 1, v40
    v_lshl_add_u32 v43, v40, 2, v43
    v_lshrrev_b32 v44, 1, v43
    v_and_b32 v45, 1, v43
    v_mul_u32_u24 v45, 40, v45
    v_add_u32 v46, 0, v44
    v_mul_u32_u24 v47, 13, v46
    v_lshrrev_b32 v47, 6, v47
    v_mul_u32_u24 v48, 5, v47
    v_sub_u32 v48, v46, v48
    v_mul_u32_u24 v49, 80, v47
    v_lshl_add_u32 v49, v48, 3, v49
    v_add_u32 v49, v49, v45
    v_add_u32 v52, v42, v49
    v_add_u32 v46, 4, v44
    v_mul_u32_u24 v47, 13, v46
    v_lshrrev_b32 v47, 6, v47
    v_mul_u32_u24 v48, 5, v47
    v_sub_u32 v48, v46, v48
    v_mul_u32_u24 v49, 80, v47
    v_lshl_add_u32 v49, v48, 3, v49
    v_add_u32 v49, v49, v45
    v_add_u32 v53, v42, v49
    v_add_u32 v46, 8, v44
    v_mul_u32_u24 v47, 13, v46
    v_lshrrev_b32 v47, 6, v47
    v_mul_u32_u24 v48, 5, v47
    v_sub_u32 v48, v46, v48
    v_mul_u32_u24 v49, 80, v47
    v_lshl_add_u32 v49, v48, 3, v49
    v_add_u32 v49, v49, v45
    v_add_u32 v54, v42, v49
    v_add_u32 v46, 12, v44
    v_mul_u32_u24 v47, 13, v46
    v_lshrrev_b32 v47, 6, v47
    v_mul_u32_u24 v48, 5, v47
    v_sub_u32 v48, v46, v48
    v_mul_u32_u24 v49, 80, v47
    v_lshl_add_u32 v49, v48, 3, v49
    v_add_u32 v49, v49, v45
    v_cmp_eq_u32 vcc, 3, v47
    v_mov_b32 v50, 240
    s_nop 0
    v_cndmask_b32 v49, v49, v50, vcc
    v_add_u32 v55, v42, v49
    s_and_b32 s52, s2, 7
    s_mul_i32 s52, s52, 5
    s_lshr_b32 s53, s2, 5
    s_add_u32 s52, s52, s53
    s_lshr_b32 s53, s2, 3
    s_and_b32 s53, s53, 3
    s_lshl_b32 s53, s53, 2
    s_add_u32 s53, s53, s3
    s_mul_i32 s53, s53, 40
    s_add_u32 s52, s52, s53
    s_lshl_b32 s52, s52, 12
    s_add_u32 s75, s52, 4194304
    s_cmp_lt_u32 s2, 160
    s_cselect_b32 s53, 0, 1073741824
    v_add_u32 v56, s53, v2
    s_waitcnt vmcnt(2)
    ds_read_b64_tr_b16 v[64:65], v52 offset:0
    ds_read_b64_tr_b16 v[66:67], v52 offset:1024
    ds_read_b64_tr_b16 v[68:69], v53 offset:0
    ds_read_b64_tr_b16 v[70:71], v53 offset:1024
    ds_read_b64_tr_b16 v[72:73], v54 offset:0
    ds_read_b64_tr_b16 v[74:75], v54 offset:1024
    ds_read_b64_tr_b16 v[76:77], v55 offset:0
    ds_read_b64_tr_b16 v[78:79], v55 offset:1024
    s_waitcnt lgkmcnt(6)
    buffer_store_dwordx4 v[64:67], v56, s[28:31], s75 offen offset:0 sc1
    s_waitcnt lgkmcnt(4)
    buffer_store_dwordx4 v[68:71], v56, s[28:31], s75 offen offset:1024 sc1
    s_waitcnt lgkmcnt(2)
    buffer_store_dwordx4 v[72:75], v56, s[28:31], s75 offen offset:2048 sc1
    s_waitcnt lgkmcnt(0)
    buffer_store_dwordx4 v[76:79], v56, s[28:31], s75 offen offset:3072 sc1
    v_add_co_u32 v4, vcc, 1, v4
    s_nop 1
    v_addc_co_u32 v5, vcc, 0, v5, vcc
    v_readfirstlane_b32 s44, v4
    v_readfirstlane_b32 s45, v5
    s_waitcnt vmcnt(4)
    s_barrier
    s_cmp_lg_u32 s3, 0
    s_cbranch_scc1 L_lnf_5
    s_lshl_b32 s63, s2, 7
    s_add_u32 s63, s63, 4096
    buffer_store_dwordx2 v[4:5], v3, s[28:31], s63 offen sc1
L_lnf_5:
    s_waitcnt vmcnt(0)
    s_lshl_b32 s63, s2, 7
    s_lshl_b32 s62, s3, 3
    s_add_u32 s63, s63, s62
    s_add_u32 s63, s63, 36864
    buffer_store_dwordx2 v[4:5], v3, s[28:31], s63 offen sc1
    s_add_u32 s66, s50, 0
    s_and_b32 s66, s66, 3
    s_lshl_b32 s66, s66, 2
    s_add_u32 s66, s66, s3
    s_mul_i32 s66, s66, 122880
    s_mul_i32 s67, s3, 5120
    s_add_u32 m0, s67, 0
    s_nop 0
    buffer_load_dwordx4 v7, s[12:15], s66 offen lds
    s_add_u32 m0, m0, 20480
    s_nop 0
    buffer_load_dwordx4 v7, s[16:19], s66 offen lds
    s_add_u32 m0, m0, 4294947840
    s_add_u32 s66, s66, 24576
    buffer_load_dwordx4 v7, s[12:15], s66 offen lds
    s_add_u32 m0, m0, 20480
    s_nop 0
    buffer_load_dwordx4 v7, s[16:19], s66 offen lds
    s_add_u32 m0, m0, 4294947840
    s_add_u32 s66, s66, 24576
    buffer_load_dwordx4 v7, s[12:15], s66 offen lds
    s_add_u32 m0, m0, 20480
    s_nop 0
    buffer_load_dwordx4 v7, s[16:19], s66 offen lds
    s_add_u32 m0, m0, 4294947840
    s_add_u32 s66, s66, 24576
    buffer_load_dwordx4 v7, s[12:15], s66 offen lds
    s_add_u32 m0, m0, 20480
    s_nop 0
    buffer_load_dwordx4 v7, s[16:19], s66 offen lds
    s_add_u32 m0, m0, 4294947840
    s_add_u32 s66, s66, 24576
    buffer_load_dwordx4 v7, s[12:15], s66 offen lds
    s_add_u32 m0, m0, 20480
    s_nop 0
    buffer_load_dwordx4 v7, s[16:19], s66 offen lds
    s_cmp_eq_u32 s3, 0
    s_cbranch_scc1 L_x1e_6
    s_add_u32 s66, s50, 1
    s_and_b32 s66, s66, 3
    s_lshl_b32 s66, s66, 2
    s_add_u32 s66, s66, s3
    s_mul_i32 s66, s66, 122880
    s_mul_i32 s67, s3, 5120
    s_add_u32 m0, s67, 40960
    s_nop 0
    buffer_load_dwordx4 v7, s[12:15], s66 offen lds
    s_add_u32 m0, m0, 20480
    s_nop 0
    buffer_load_dwordx4 v7, s[16:19], s66 offen lds
    s_add_u32 m0, m0, 4294947840
    s_add_u32 s66, s66, 24576
    buffer_load_dwordx4 v7, s[12:15], s66 offen lds
    s_add_u32 m0, m0, 20480
    s_nop 0
    buffer_load_dwordx4 v7, s[16:19], s66 offen lds
    s_add_u32 m0, m0, 4294947840
    s_add_u32 s66, s66, 24576
    buffer_load_dwordx4 v7, s[12:15], s66 offen lds
    s_add_u32 m0, m0, 20480
    s_nop 0
    buffer_load_dwordx4 v7, s[16:19], s66 offen lds
    s_add_u32 m0, m0, 4294947840
    s_add_u32 s66, s66, 24576
    buffer_load_dwordx4 v7, s[12:15], s66 offen lds
    s_add_u32 m0, m0, 20480
    s_nop 0
    buffer_load_dwordx4 v7, s[16:19], s66 offen lds
    s_add_u32 m0, m0, 4294947840
    s_add_u32 s66, s66, 24576
    buffer_load_dwordx4 v7, s[12:15], s66 offen lds
    s_add_u32 m0, m0, 20480
    s_nop 0
    buffer_load_dwordx4 v7, s[16:19], s66 offen lds
L_x1e_6:
    s_lshl_b32 s86, s2, 2
    s_add_u32 s86, s86, s3
    s_mul_i32 s87, s86, 6554
    s_lshr_b32 s87, s87, 16
    s_mul_i32 s88, s87, 10
    s_sub_u32 s88, s86, s88
    s_cmp_lt_u32 s87, 48
    s_cselect_b32 s40, s20, s24
    s_cselect_b32 s41, s21, s25
    s_cselect_b32 s42, s22, s26
    s_mov_b32 s43, 0x20000
    v_lshrrev_b32 v84, 3, v1
    v_and_b32 v85, 7, v1
    v_and_b32 v86, 3, v84
    v_mul_u32_u24 v86, 1280, v86
    v_lshl_add_u32 v86, v85, 4, v86
    s_cmp_lt_u32 s86, 680
    s_cselect_b32 s89, 0, 1073741824
    v_add_u32 v86, s89, v86
    v_add_u32 v189, s89, v2
    v_lshrrev_b32 v87, 2, v84
    s_lshl_b32 s89, s87, 5
    s_add_u32 s89, s89, 0
    s_sub_u32 s96, s87, 48
    s_lshl_b32 s96, s96, 2
    s_add_u32 s96, s96, 0
    s_mul_i32 s97, s96, 205
    s_lshr_b32 s97, s97, 10
    s_mul_i32 s54, s97, 5
    s_sub_u32 s96, s96, s54
    s_mul_i32 s97, s97, 40
    s_lshl_b32 s54, s96, 3
    s_add_u32 s97, s97, s54
    s_cmp_ge_u32 s96, 2
    s_cselect_b32 s54, 4, 0
    s_add_u32 s97, s97, s54
    s_cmp_eq_u32 s96, 4
    s_cselect_b32 s54, 20, 0
    s_sub_u32 s97, s97, s54
    s_cmp_eq_u32 s96, 4
    s_cselect_b32 s54, 20, 4
    s_cmp_lt_u32 s87, 48
    s_cselect_b32 s89, s89, s97
    s_cselect_b32 s54, 8, s54
    s_mul_i32 s54, s54, 1280
    s_mul_i32 s89, s89, 1280
    s_lshl_b32 s96, s88, 7
    s_add_u32 s89, s89, s96
    v_mad_u32_u24 v184, v87, s54, v86
    v_add_u32 v184, s89, v184
    s_lshl_b32 s89, s87, 5
    s_add_u32 s89, s89, 4
    s_sub_u32 s96, s87, 48
    s_lshl_b32 s96, s96, 2
    s_add_u32 s96, s96, 1
    s_mul_i32 s97, s96, 205
    s_lshr_b32 s97, s97, 10
    s_mul_i32 s54, s97, 5
    s_sub_u32 s96, s96, s54
    s_mul_i32 s97, s97, 40
    s_lshl_b32 s54, s96, 3
    s_add_u32 s97, s97, s54
    s_cmp_ge_u32 s96, 2
    s_cselect_b32 s54, 4, 0
    s_add_u32 s97, s97, s54
    s_cmp_eq_u32 s96, 4
    s_cselect_b32 s54, 20, 0
    s_sub_u32 s97, s97, s54
    s_cmp_eq_u32 s96, 4
    s_cselect_b32 s54, 20, 4
    s_cmp_lt_u32 s87, 48
    s_cselect_b32 s89, s89, s97
    s_cselect_b32 s54, 8, s54
    s_mul_i32 s54, s54, 1280
    s_mul_i32 s89, s89, 1280
    s_lshl_b32 s96, s88, 7
    s_add_u32 s89, s89, s96
    v_mad_u32_u24 v185, v87, s54, v86
    v_add_u32 v185, s89, v185
    s_lshl_b32 s89, s87, 5
    s_add_u32 s89, s89, 16
    s_sub_u32 s96, s87, 48
    s_lshl_b32 s96, s96, 2
    s_add_u32 s96, s96, 2
    s_mul_i32 s97, s96, 205
    s_lshr_b32 s97, s97, 10
    s_mul_i32 s54, s97, 5
    s_sub_u32 s96, s96, s54
    s_mul_i32 s97, s97, 40
    s_lshl_b32 s54, s96, 3
    s_add_u32 s97, s97, s54
    s_cmp_ge_u32 s96, 2
    s_cselect_b32 s54, 4, 0
    s_add_u32 s97, s97, s54
    s_cmp_eq_u32 s96, 4
    s_cselect_b32 s54, 20, 0
    s_sub_u32 s97, s97, s54
    s_cmp_eq_u32 s96, 4
    s_cselect_b32 s54, 20, 4
    s_cmp_lt_u32 s87, 48
    s_cselect_b32 s89, s89, s97
    s_cselect_b32 s54, 8, s54
    s_mul_i32 s54, s54, 1280
    s_mul_i32 s89, s89, 1280
    s_lshl_b32 s96, s88, 7
    s_add_u32 s89, s89, s96
    v_mad_u32_u24 v186, v87, s54, v86
    v_add_u32 v186, s89, v186
    s_lshl_b32 s89, s87, 5
    s_add_u32 s89, s89, 20
    s_sub_u32 s96, s87, 48
    s_lshl_b32 s96, s96, 2
    s_add_u32 s96, s96, 3
    s_mul_i32 s97, s96, 205
    s_lshr_b32 s97, s97, 10
    s_mul_i32 s54, s97, 5
    s_sub_u32 s96, s96, s54
    s_mul_i32 s97, s97, 40
    s_lshl_b32 s54, s96, 3
    s_add_u32 s97, s97, s54
    s_cmp_ge_u32 s96, 2
    s_cselect_b32 s54, 4, 0
    s_add_u32 s97, s97, s54
    s_cmp_eq_u32 s96, 4
    s_cselect_b32 s54, 20, 0
    s_sub_u32 s97, s97, s54
    s_cmp_eq_u32 s96, 4
    s_cselect_b32 s54, 20, 4
    s_cmp_lt_u32 s87, 48
    s_cselect_b32 s89, s89, s97
    s_cselect_b32 s54, 8, s54
    s_mul_i32 s54, s54, 1280
    s_mul_i32 s89, s89, 1280
    s_lshl_b32 s96, s88, 7
    s_add_u32 s89, s89, s96
    v_mad_u32_u24 v187, v87, s54, v86
    v_add_u32 v187, s89, v187
    v_lshrrev_b32 v84, 4, v1
    v_and_b32 v85, 15, v1
    v_lshrrev_b32 v86, 2, v85
    v_lshl_add_u32 v86, v84, 3, v86
    v_lshlrev_b32 v86, 7, v86
    v_and_b32 v87, 3, v85
    v_lshl_add_u32 v86, v87, 3, v86
    s_lshl_b32 s89, s3, 12
    s_add_u32 s89, s89, 122880
    v_add_u32 v188, s89, v86
    s_lshl_b32 s89, s88, 2
    s_add_u32 s89, s89, 0
    s_mul_i32 s96, s89, 205
    s_lshr_b32 s96, s96, 10
    s_mul_i32 s97, s96, 5
    s_sub_u32 s89, s89, s97
    s_mul_i32 s96, s96, 68
    s_add_u32 s96, s96, s87
    s_mul_i32 s96, s96, 5
    s_add_u32 s96, s96, s89
    s_lshl_b32 s96, s96, 10
    s_add_u32 s98, s96, 7340032
    s_lshl_b32 s89, s88, 2
    s_add_u32 s89, s89, 1
    s_mul_i32 s96, s89, 205
    s_lshr_b32 s96, s96, 10
    s_mul_i32 s97, s96, 5
    s_sub_u32 s89, s89, s97
    s_mul_i32 s96, s96, 68
    s_add_u32 s96, s96, s87
    s_mul_i32 s96, s96, 5
    s_add_u32 s96, s96, s89
    s_lshl_b32 s96, s96, 10
    s_add_u32 s99, s96, 7340032
    s_lshl_b32 s89, s88, 2
    s_add_u32 s89, s89, 2
    s_mul_i32 s96, s89, 205
    s_lshr_b32 s96, s96, 10
    s_mul_i32 s97, s96, 5
    s_sub_u32 s89, s89, s97
    s_mul_i32 s96, s96, 68
    s_add_u32 s96, s96, s87
    s_mul_i32 s96, s96, 5
    s_add_u32 s96, s96, s89
    s_lshl_b32 s96, s96, 10
    s_add_u32 s100, s96, 7340032
    s_lshl_b32 s89, s88, 2
    s_add_u32 s89, s89, 3
    s_mul_i32 s96, s89, 205
    s_lshr_b32 s96, s96, 10
    s_mul_i32 s97, s96, 5
    s_sub_u32 s89, s89, s97
    s_mul_i32 s96, s96, 68
    s_add_u32 s96, s96, s87
    s_mul_i32 s96, s96, 5
    s_add_u32 s96, s96, s89
    s_lshl_b32 s96, s96, 10
    s_add_u32 s101, s96, 7340032
    s_cmp_lg_u32 s3, 0
    s_cbranch_scc1 L_pw1_7
    v_and_b32 v14, 3, v1
    v_lshlrev_b32 v14, 3, v14
    v_bfe_u32 v15, v1, 2, 2
    v_add_u32 v15, 0, v15
    v_and_b32 v15, 3, v15
    v_add_u32 v14, v14, v15
    v_lshlrev_b32 v14, 7, v14
    s_and_b32 s52, s46, 7
    s_lshl_b32 s52, s52, 5
    s_lshr_b32 s53, s46, 3
    s_lshl_b32 s53, s53, 2
    s_add_u32 s52, s52, s53
    s_lshl_b32 s52, s52, 7
    s_add_u32 s65, s52, 4096
    s_mov_b32 s64, 0
L_spin_8:
    buffer_load_dwordx2 v[16:17], v14, s[28:31], s65 offen sc1
    s_waitcnt vmcnt(0)
    v_cmp_ne_u64 vcc, s[44:45], v[16:17]
    s_nop 0
    s_cbranch_vccz L_spun_9
    s_add_u32 s64, s64, 1
    s_cmp_lt_u32 s64, 200000
    s_cbranch_scc1 L_spin_8
L_spun_9:
    s_branch L_pw2_10
L_pw1_7:
    s_cmp_lg_u32 s3, 3
    s_cbranch_scc1 L_pw2_10
    s_call_b64 s[62:63], L_pad0
    s_call_b64 s[62:63], L_pad1
    s_call_b64 s[62:63], L_pad2
    s_call_b64 s[62:63], L_pad3
    s_call_b64 s[62:63], L_pad4
    s_call_b64 s[62:63], L_pad5
    s_nop 0
    s_nop 0
    s_nop 0
    s_nop 0
    s_nop 0
    s_nop 0
L_pw2_10:
    s_waitcnt vmcnt(10)
    s_barrier
    s_lshl_b32 s83, s46, 2
    s_add_u32 s83, s83, s3
    s_mul_i32 s83, s83, 40960
    s_add_u32 s83, s83, 1048576
    s_add_u32 s59, s50, 0
    s_and_b32 s59, s59, 3
    s_mul_i32 s59, s59, 10240
    s_add_u32 s60, s83, s59
    buffer_load_dwordx4 a[0:3], v2, s[28:31], s60 offen offset:0 sc1
    buffer_load_dwordx4 a[4:7], v2, s[28:31], s60 offen offset:1024 sc1
    buffer_load_dwordx4 a[8:11], v2, s[28:31], s60 offen offset:2048 sc1
    buffer_load_dwordx4 a[12:15], v2, s[28:31], s60 offen offset:3072 sc1
    s_add_u32 s60, s60, 4096
    buffer_load_dwordx4 a[16:19], v2, s[28:31], s60 offen offset:0 sc1
    buffer_load_dwordx4 a[20:23], v2, s[28:31], s60 offen offset:1024 sc1
    v_lshrrev_b32 v100, 5, v1
    v_bfe_u32 v101, v1, 2, 2
    v_bfe_u32 v102, v1, 4, 1
    v_and_b32 v103, 3, v1
    v_lshl_add_u32 v103, v102, 2, v103
    v_lshrrev_b32 v104, 1, v103
    v_and_b32 v103, 1, v103
    v_mul_u32_u24 v105, 40, v101
    v_mul_u32_u24 v106, 800, v100
    v_add_u32 v106, v106, v105
    v_add_u32 v106, 160000, v106
    v_add_u32 v107, 162880, v105
    v_add_u32 v108, 0, v104
    v_lshl_add_u32 v109, v108, 3, v106
    v_cmp_eq_u32 vcc, v100, v103
    s_nop 1
    v_cndmask_b32 v109, v107, v109, vcc
    v_cmp_gt_u32 vcc, 5, v108
    s_nop 1
    v_cndmask_b32 v109, v107, v109, vcc
    ds_read_b64_tr_b16 a[192:193], v109 offset:0
    ds_read_b64_tr_b16 a[194:195], v109 offset:160
    ds_read_b64_tr_b16 a[196:197], v109 offset:320
    ds_read_b64_tr_b16 a[198:199], v109 offset:480
    ds_read_b64_tr_b16 a[200:201], v109 offset:640
    v_accvgpr_write_b32 a202, 0
    v_accvgpr_write_b32 a203, 0
    v_add_u32 v108, 4, v104
    v_lshl_add_u32 v109, v108, 3, v106
    v_cmp_eq_u32 vcc, v100, v103
    s_nop 1
    v_cndmask_b32 v109, v107, v109, vcc
    v_cmp_gt_u32 vcc, 5, v108
    s_nop 1
    v_cndmask_b32 v109, v107, v109, vcc
    ds_read_b64_tr_b16 a[204:205], v109 offset:0
    ds_read_b64_tr_b16 a[206:207], v109 offset:160
    ds_read_b64_tr_b16 a[208:209], v109 offset:320
    ds_read_b64_tr_b16 a[210:211], v109 offset:480
    ds_read_b64_tr_b16 a[212:213], v109 offset:640
    v_accvgpr_write_b32 a214, 0
    v_accvgpr_write_b32 a215, 0
    s_mul_i32 s52, s49, 68
    s_mul_i32 s53, s3, 12
    s_add_u32 s53, s53, s52
    s_mul_i32 s53, s53, 5120
    s_add_u32 s81, s53, 7340032
    s_mul_i32 s53, s3, 5
    s_add_u32 s53, s53, s52
    s_add_u32 s53, s53, 48
    s_mul_i32 s53, s53, 5120
    s_add_u32 s82, s53, 7340032
    v_add_u32 v0, 4096, v2
    s_cmp_lg_u32 s3, 0
    s_cbranch_scc1 L_x1l_11
    s_add_u32 s66, s50, 1
    s_and_b32 s66, s66, 3
    s_lshl_b32 s66, s66, 2
    s_add_u32 s66, s66, s3
    s_mul_i32 s66, s66, 122880
    s_mul_i32 s67, s3, 5120
    s_add_u32 m0, s67, 40960
    s_nop 0
    buffer_load_dwordx4 v7, s[12:15], s66 offen lds
    s_add_u32 m0, m0, 20480
    s_nop 0
    buffer_load_dwordx4 v7, s[16:19], s66 offen lds
    s_add_u32 m0, m0, 4294947840
    s_add_u32 s66, s66, 24576
    buffer_load_dwordx4 v7, s[12:15], s66 offen lds
    s_add_u32 m0, m0, 20480
    s_nop 0
    buffer_load_dwordx4 v7, s[16:19], s66 offen lds
    s_add_u32 m0, m0, 4294947840
    s_add_u32 s66, s66, 24576
    buffer_load_dwordx4 v7, s[12:15], s66 offen lds
    s_add_u32 m0, m0, 20480
    s_nop 0
    buffer_load_dwordx4 v7, s[16:19], s66 offen lds
    s_add_u32 m0, m0, 4294947840
    s_add_u32 s66, s66, 24576
    buffer_load_dwordx4 v7, s[12:15], s66 offen lds
    s_add_u32 m0, m0, 20480
    s_nop 0
    buffer_load_dwordx4 v7, s[16:19], s66 offen lds
    s_add_u32 m0, m0, 4294947840
    s_add_u32 s66, s66, 24576
    buffer_load_dwordx4 v7, s[12:15], s66 offen lds
    s_add_u32 m0, m0, 20480
    s_nop 0
    buffer_load_dwordx4 v7, s[16:19], s66 offen lds
L_x1l_11:
    v_add_u32 v11, 0, v9
    v_add_u32 v12, 0, v10
    ds_read_b64_tr_b16 a[160:161], v11 offset:0
    ds_read_b64_tr_b16 a[162:163], v11 offset:512
    ds_read_b64_tr_b16 a[164:165], v12 offset:0
    ds_read_b64_tr_b16 a[166:167], v12 offset:512
    ds_read_b64_tr_b16 a[168:169], v11 offset:20480
    ds_read_b64_tr_b16 a[170:171], v11 offset:20992
    ds_read_b64_tr_b16 a[172:173], v12 offset:20480
    ds_read_b64_tr_b16 a[174:175], v12 offset:20992
    ds_read_b64_tr_b16 a[176:177], v11 offset:2048
    ds_read_b64_tr_b16 a[178:179], v11 offset:2560
    ds_read_b64_tr_b16 a[180:181], v12 offset:2048
    ds_read_b64_tr_b16 a[182:183], v12 offset:2560
    ds_read_b64_tr_b16 a[184:185], v11 offset:22528
    ds_read_b64_tr_b16 a[186:187], v11 offset:23040
    s_waitcnt lgkmcnt(6)
    s_waitcnt vmcnt(5)
    v_mfma_f32_32x32x16_bf16 v[120:135], a[160:163], a[0:3], 0
    ds_read_b64_tr_b16 a[188:189], v12 offset:22528
    ds_read_b64_tr_b16 a[190:191], v12 offset:23040
    buffer_load_dwordx4 a[24:27], v2, s[28:31], s60 offen offset:2048 sc1
    v_mfma_f32_32x32x16_bf16 v[136:151], a[164:167], a[0:3], 0
    ds_read_b64_tr_b16 a[160:161], v11 offset:4096
    ds_read_b64_tr_b16 a[162:163], v11 offset:4608
    buffer_load_dwordx4 a[28:31], v2, s[28:31], s60 offen offset:3072 sc1
    v_mfma_f32_32x32x16_bf16 v[152:167], a[168:171], a[0:3], 0
    ds_read_b64_tr_b16 a[164:165], v12 offset:4096
    ds_read_b64_tr_b16 a[166:167], v12 offset:4608
    s_add_u32 s60, s60, 4096
    buffer_load_dwordx4 a[32:35], v2, s[28:31], s60 offen offset:0 sc1
    v_mfma_f32_32x32x16_bf16 v[168:183], a[172:175], a[0:3], 0
    ds_read_b64_tr_b16 a[168:169], v11 offset:24576
    ds_read_b64_tr_b16 a[170:171], v11 offset:25088
    buffer_load_dwordx4 a[36:39], v2, s[28:31], s60 offen offset:1024 sc1
    s_waitcnt lgkmcnt(6)
    s_waitcnt vmcnt(8)
    v_mfma_f32_32x32x16_bf16 v[120:135], a[176:179], a[4:7], v[120:135]
    ds_read_b64_tr_b16 a[172:173], v12 offset:24576
    ds_read_b64_tr_b16 a[174:175], v12 offset:25088
    s_add_u32 s59, s50, 1
    s_and_b32 s59, s59, 3
    s_mul_i32 s59, s59, 10240
    s_add_u32 s60, s83, s59
    buffer_load_dwordx4 a[40:43], v2, s[28:31], s60 offen offset:0 sc1
    v_mfma_f32_32x32x16_bf16 v[136:151], a[180:183], a[4:7], v[136:151]
    ds_read_b64_tr_b16 a[176:177], v11 offset:6144
    ds_read_b64_tr_b16 a[178:179], v11 offset:6656
    buffer_load_dwordx4 a[44:47], v2, s[28:31], s60 offen offset:1024 sc1
    v_mfma_f32_32x32x16_bf16 v[152:167], a[184:187], a[4:7], v[152:167]
    ds_read_b64_tr_b16 a[180:181], v12 offset:6144
    ds_read_b64_tr_b16 a[182:183], v12 offset:6656
    buffer_load_dwordx4 a[48:51], v2, s[28:31], s60 offen offset:2048 sc1
    v_mfma_f32_32x32x16_bf16 v[168:183], a[188:191], a[4:7], v[168:183]
    ds_read_b64_tr_b16 a[184:185], v11 offset:26624
    ds_read_b64_tr_b16 a[186:187], v11 offset:27136
    buffer_load_dwordx4 a[52:55], v2, s[28:31], s60 offen offset:3072 sc1
    s_waitcnt lgkmcnt(6)
    s_waitcnt vmcnt(11)
    v_mfma_f32_32x32x16_bf16 v[120:135], a[160:163], a[8:11], v[120:135]
    ds_read_b64_tr_b16 a[188:189], v12 offset:26624
    ds_read_b64_tr_b16 a[190:191], v12 offset:27136
    s_add_u32 s60, s60, 4096
    buffer_load_dwordx4 a[56:59], v2, s[28:31], s60 offen offset:0 sc1
    v_mfma_f32_32x32x16_bf16 v[136:151], a[164:167], a[8:11], v[136:151]
    ds_read_b64_tr_b16 a[160:161], v11 offset:8192
    ds_read_b64_tr_b16 a[162:163], v11 offset:8704
    buffer_load_dwordx4 a[60:63], v2, s[28:31], s60 offen offset:1024 sc1
    v_mfma_f32_32x32x16_bf16 v[152:167], a[168:171], a[8:11], v[152:167]
    ds_read_b64_tr_b16 a[164:165], v12 offset:8192
    ds_read_b64_tr_b16 a[166:167], v12 offset:8704
    buffer_load_dwordx4 a[64:67], v2, s[28:31], s60 offen offset:2048 sc1
    v_mfma_f32_32x32x16_bf16 v[168:183], a[172:175], a[8:11], v[168:183]
    ds_read_b64_tr_b16 a[168:169], v11 offset:28672
    ds_read_b64_tr_b16 a[170:171], v11 offset:29184
    buffer_load_dwordx4 a[68:71], v2, s[28:31], s60 offen offset:3072 sc1
    s_waitcnt lgkmcnt(6)
    s_waitcnt vmcnt(14)
    v_mfma_f32_32x32x16_bf16 v[120:135], a[176:179], a[12:15], v[120:135]
    ds_read_b64_tr_b16 a[172:173], v12 offset:28672
    ds_read_b64_tr_b16 a[174:175], v12 offset:29184
    s_add_u32 s60, s60, 4096
    buffer_load_dwordx4 a[72:75], v2, s[28:31], s60 offen offset:0 sc1
    v_mfma_f32_32x32x16_bf16 v[136:151], a[180:183], a[12:15], v[136:151]
    ds_read_b64_tr_b16 a[176:177], v11 offset:10240
    ds_read_b64_tr_b16 a[178:179], v11 offset:10752
    buffer_load_dwordx4 a[76:79], v2, s[28:31], s60 offen offset:1024 sc1
    v_mfma_f32_32x32x16_bf16 v[152:167], a[184:187], a[12:15], v[152:167]
    ds_read_b64_tr_b16 a[180:181], v12 offset:10240
    ds_read_b64_tr_b16 a[182:183], v12 offset:10752
    v_mfma_f32_32x32x16_bf16 v[168:183], a[188:191], a[12:15], v[168:183]
    ds_read_b64_tr_b16 a[184:185], v11 offset:30720
    ds_read_b64_tr_b16 a[186:187], v11 offset:31232
    s_waitcnt lgkmcnt(6)
    s_waitcnt vmcnt(15)
    v_mfma_f32_32x32x16_bf16 v[120:135], a[160:163], a[16:19], v[120:135]
    ds_read_b64_tr_b16 a[188:189], v12 offset:30720
    ds_read_b64_tr_b16 a[190:191], v12 offset:31232
    v_mfma_f32_32x32x16_bf16 v[136:151], a[164:167], a[16:19], v[136:151]
    ds_read_b64_tr_b16 a[160:161], v11 offset:12288
    ds_read_b64_tr_b16 a[162:163], v11 offset:12800
    v_mfma_f32_32x32x16_bf16 v[152:167], a[168:171], a[16:19], v[152:167]
    ds_read_b64_tr_b16 a[164:165], v12 offset:12288
    ds_read_b64_tr_b16 a[166:167], v12 offset:12800
    v_min_u32 v14, 39, v1
    v_mul_u32_u24 v15, 205, v14
    v_lshrrev_b32 v15, 10, v15
    v_mul_u32_u24 v248, 5, v15
    v_mfma_f32_32x32x16_bf16 v[168:183], a[172:175], a[16:19], v[168:183]
    ds_read_b64_tr_b16 a[168:169], v11 offset:32768
    ds_read_b64_tr_b16 a[170:171], v11 offset:33280
    v_sub_u32 v14, v14, v248
    v_lshl_add_u32 v14, v14, 5, v15
    v_lshlrev_b32 v14, 7, v14
    s_lshr_b32 s52, s47, 2
    s_waitcnt lgkmcnt(6)
    s_waitcnt vmcnt(14)
    v_mfma_f32_32x32x16_bf16 v[120:135], a[176:179], a[20:23], v[120:135]
    ds_read_b64_tr_b16 a[172:173], v12 offset:32768
    ds_read_b64_tr_b16 a[174:175], v12 offset:33280
    s_lshl_b32 s52, s52, 10
    s_and_b32 s53, s47, 3
    s_lshl_b32 s53, s53, 3
    s_add_u32 s52, s52, s53
    v_mfma_f32_32x32x16_bf16 v[136:151], a[180:183], a[20:23], v[136:151]
    ds_read_b64_tr_b16 a[176:177], v11 offset:14336
    ds_read_b64_tr_b16 a[178:179], v11 offset:14848
    s_add_u32 s65, s52, 36864
    buffer_load_dwordx2 v[16:17], v14, s[28:31], s65 offen sc1
    v_mfma_f32_32x32x16_bf16 v[152:167], a[184:187], a[20:23], v[152:167]
    ds_read_b64_tr_b16 a[180:181], v12 offset:14336
    ds_read_b64_tr_b16 a[182:183], v12 offset:14848
    v_mfma_f32_32x32x16_bf16 v[168:183], a[188:191], a[20:23], v[168:183]
    ds_read_b64_tr_b16 a[184:185], v11 offset:34816
    ds_read_b64_tr_b16 a[186:187], v11 offset:35328
    s_waitcnt lgkmcnt(6)
    s_waitcnt vmcnt(14)
    v_mfma_f32_32x32x16_bf16 v[120:135], a[160:163], a[24:27], v[120:135]
    ds_read_b64_tr_b16 a[188:189], v12 offset:34816
    ds_read_b64_tr_b16 a[190:191], v12 offset:35328
    v_mfma_f32_32x32x16_bf16 v[136:151], a[164:167], a[24:27], v[136:151]
    ds_read_b64_tr_b16 a[160:161], v11 offset:16384
    ds_read_b64_tr_b16 a[162:163], v11 offset:16896
    v_mfma_f32_32x32x16_bf16 v[152:167], a[168:171], a[24:27], v[152:167]
    ds_read_b64_tr_b16 a[164:165], v12 offset:16384
    ds_read_b64_tr_b16 a[166:167], v12 offset:16896
    v_mfma_f32_32x32x16_bf16 v[168:183], a[172:175], a[24:27], v[168:183]
    ds_read_b64_tr_b16 a[168:169], v11 offset:36864
    ds_read_b64_tr_b16 a[170:171], v11 offset:37376
    s_waitcnt lgkmcnt(6)
    s_waitcnt vmcnt(13)
    v_mfma_f32_32x32x16_bf16 v[120:135], a[176:179], a[28:31], v[120:135]
    ds_read_b64_tr_b16 a[172:173], v12 offset:36864
    ds_read_b64_tr_b16 a[174:175], v12 offset:37376
    v_mfma_f32_32x32x16_bf16 v[136:151], a[180:183], a[28:31], v[136:151]
    ds_read_b64_tr_b16 a[176:177], v11 offset:18432
    ds_read_b64_tr_b16 a[178:179], v11 offset:18944
    v_mfma_f32_32x32x16_bf16 v[152:167], a[184:187], a[28:31], v[152:167]
    ds_read_b64_tr_b16 a[180:181], v12 offset:18432
    ds_read_b64_tr_b16 a[182:183], v12 offset:18944
    v_mfma_f32_32x32x16_bf16 v[168:183], a[188:191], a[28:31], v[168:183]
    ds_read_b64_tr_b16 a[184:185], v11 offset:38912
    ds_read_b64_tr_b16 a[186:187], v11 offset:39424
    s_waitcnt lgkmcnt(6)
    s_waitcnt vmcnt(12)
    v_mfma_f32_32x32x16_bf16 v[120:135], a[160:163], a[32:35], v[120:135]
    ds_read_b64_tr_b16 a[188:189], v12 offset:38912
    ds_read_b64_tr_b16 a[190:191], v12 offset:39424
    v_mfma_f32_32x32x16_bf16 v[136:151], a[164:167], a[32:35], v[136:151]
    v_mfma_f32_32x32x16_bf16 v[152:167], a[168:171], a[32:35], v[152:167]
    v_mfma_f32_32x32x16_bf16 v[168:183], a[172:175], a[32:35], v[168:183]
    s_waitcnt lgkmcnt(0)
    s_barrier
    v_add_u32 v11, 40960, v9
    v_add_u32 v12, 40960, v10
    ds_read_b64_tr_b16 a[160:161], v11 offset:0
    ds_read_b64_tr_b16 a[162:163], v11 offset:512
    ds_read_b64_tr_b16 a[164:165], v12 offset:0
    ds_read_b64_tr_b16 a[166:167], v12 offset:512
    s_add_u32 s59, s50, 2
    s_and_b32 s59, s59, 3
    s_mul_i32 s59, s59, 10240
    s_add_u32 s60, s83, s59
    buffer_load_dwordx4 a[80:83], v2, s[28:31], s60 offen offset:0 sc1
    s_waitcnt vmcnt(12)
    v_mfma_f32_32x32x16_bf16 v[120:135], a[176:179], a[36:39], v[120:135]
    ds_read_b64_tr_b16 a[168:169], v11 offset:20480
    ds_read_b64_tr_b16 a[170:171], v11 offset:20992
    ds_read_b64_tr_b16 a[172:173], v12 offset:20480
    ds_read_b64_tr_b16 a[174:175], v12 offset:20992
    v_mfma_f32_32x32x16_bf16 v[136:151], a[180:183], a[36:39], v[136:151]
    ds_read_b64_tr_b16 a[176:177], v11 offset:2048
    ds_read_b64_tr_b16 a[178:179], v11 offset:2560
    buffer_load_dwordx4 a[84:87], v2, s[28:31], s60 offen offset:1024 sc1
    v_mfma_f32_32x32x16_bf16 v[152:167], a[184:187], a[36:39], v[152:167]
    ds_read_b64_tr_b16 a[180:181], v12 offset:2048
    ds_read_b64_tr_b16 a[182:183], v12 offset:2560
    v_mfma_f32_32x32x16_bf16 v[168:183], a[188:191], a[36:39], v[168:183]
    ds_read_b64_tr_b16 a[184:185], v11 offset:22528
    ds_read_b64_tr_b16 a[186:187], v11 offset:23040
    buffer_load_dwordx4 a[88:91], v2, s[28:31], s60 offen offset:2048 sc1
    s_waitcnt lgkmcnt(6)
    s_waitcnt vmcnt(13)
    v_mfma_f32_32x32x16_bf16 v[120:135], a[160:163], a[40:43], v[120:135]
    s_waitcnt vmcnt(3)
    v_cmp_ne_u64 vcc, s[44:45], v[16:17]
    s_nop 0
    s_cbranch_vccnz L_slow_12
L_back_13:
    ds_read_b64_tr_b16 a[188:189], v12 offset:22528
    ds_read_b64_tr_b16 a[190:191], v12 offset:23040
    v_mfma_f32_32x32x16_bf16 v[136:151], a[164:167], a[40:43], v[136:151]
    ds_read_b64_tr_b16 a[160:161], v11 offset:4096
    ds_read_b64_tr_b16 a[162:163], v11 offset:4608
    s_add_u32 s67, s50, 0
    s_and_b32 s67, s67, 3
    s_lshl_b32 s66, s47, 2
    s_add_u32 s66, s66, s67
    s_mul_i32 s66, s66, 40960
    s_mul_i32 s67, s3, 10240
    s_add_u32 s66, s66, s67
    s_add_u32 s66, s66, 4194304
    s_add_u32 m0, s67, 81920
    s_nop 0
    buffer_load_dwordx4 v2, s[28:31], s66 offen offset:0 sc1 lds
    v_mfma_f32_32x32x16_bf16 v[152:167], a[168:171], a[40:43], v[152:167]
    ds_read_b64_tr_b16 a[164:165], v12 offset:4096
    ds_read_b64_tr_b16 a[166:167], v12 offset:4608
    v_mfma_f32_32x32x16_bf16 v[168:183], a[172:175], a[40:43], v[168:183]
    ds_read_b64_tr_b16 a[168:169], v11 offset:24576
    ds_read_b64_tr_b16 a[170:171], v11 offset:25088
    buffer_load_dwordx4 v2, s[28:31], s66 offen offset:1024 sc1 lds
    s_waitcnt lgkmcnt(6)
    v_mfma_f32_32x32x16_bf16 v[120:135], a[176:179], a[44:47], v[120:135]
    ds_read_b64_tr_b16 a[172:173], v12 offset:24576
    ds_read_b64_tr_b16 a[174:175], v12 offset:25088
    v_mfma_f32_32x32x16_bf16 v[136:151], a[180:183], a[44:47], v[136:151]
    ds_read_b64_tr_b16 a[176:177], v11 offset:6144
    ds_read_b64_tr_b16 a[178:179], v11 offset:6656
    buffer_load_dwordx4 v2, s[28:31], s66 offen offset:2048 sc1 lds
    v_mfma_f32_32x32x16_bf16 v[152:167], a[184:187], a[44:47], v[152:167]
    ds_read_b64_tr_b16 a[180:181], v12 offset:6144
    ds_read_b64_tr_b16 a[182:183], v12 offset:6656
    v_mfma_f32_32x32x16_bf16 v[168:183], a[188:191], a[44:47], v[168:183]
    ds_read_b64_tr_b16 a[184:185], v11 offset:26624
    ds_read_b64_tr_b16 a[186:187], v11 offset:27136
    buffer_load_dwordx4 v2, s[28:31], s66 offen offset:3072 sc1 lds
    s_waitcnt lgkmcnt(6)
    v_mfma_f32_32x32x16_bf16 v[120:135], a[160:163], a[48:51], v[120:135]
    ds_read_b64_tr_b16 a[188:189], v12 offset:26624
    ds_read_b64_tr_b16 a[190:191], v12 offset:27136
    v_mfma_f32_32x32x16_bf16 v[136:151], a[164:167], a[48:51], v[136:151]
    ds_read_b64_tr_b16 a[160:161], v11 offset:8192
    ds_read_b64_tr_b16 a[162:163], v11 offset:8704
    s_add_u32 m0, m0, 4096
    s_add_u32 s66, s66, 4096
    buffer_load_dwordx4 v2, s[28:31], s66 offen offset:0 sc1 lds
    v_mfma_f32_32x32x16_bf16 v[152:167], a[168:171], a[48:51], v[152:167]
    ds_read_b64_tr_b16 a[164:165], v12 offset:8192
    ds_read_b64_tr_b16 a[166:167], v12 offset:8704
    v_mfma_f32_32x32x16_bf16 v[168:183], a[172:175], a[48:51], v[168:183]
    ds_read_b64_tr_b16 a[168:169], v11 offset:28672
    ds_read_b64_tr_b16 a[170:171], v11 offset:29184
    buffer_load_dwordx4 v2, s[28:31], s66 offen offset:1024 sc1 lds
    s_waitcnt lgkmcnt(6)
    v_mfma_f32_32x32x16_bf16 v[120:135], a[176:179], a[52:55], v[120:135]
    ds_read_b64_tr_b16 a[172:173], v12 offset:28672
    ds_read_b64_tr_b16 a[174:175], v12 offset:29184
    v_mfma_f32_32x32x16_bf16 v[136:151], a[180:183], a[52:55], v[136:151]
    ds_read_b64_tr_b16 a[176:177], v11 offset:10240
    ds_read_b64_tr_b16 a[178:179], v11 offset:10752
    buffer_load_dwordx4 v2, s[28:31], s66 offen offset:2048 sc1 lds
    v_mfma_f32_32x32x16_bf16 v[152:167], a[184:187], a[52:55], v[152:167]
    ds_read_b64_tr_b16 a[180:181], v12 offset:10240
    ds_read_b64_tr_b16 a[182:183], v12 offset:10752
    v_mfma_f32_32x32x16_bf16 v[168:183], a[188:191], a[52:55], v[168:183]
    ds_read_b64_tr_b16 a[184:185], v11 offset:30720
    ds_read_b64_tr_b16 a[186:187], v11 offset:31232
    buffer_load_dwordx4 v2, s[28:31], s66 offen offset:3072 sc1 lds
    s_waitcnt lgkmcnt(6)
    v_mfma_f32_32x32x16_bf16 v[120:135], a[160:163], a[56:59], v[120:135]
    ds_read_b64_tr_b16 a[188:189], v12 offset:30720
    ds_read_b64_tr_b16 a[190:191], v12 offset:31232
    v_mfma_f32_32x32x16_bf16 v[136:151], a[164:167], a[56:59], v[136:151]
    ds_read_b64_tr_b16 a[160:161], v11 offset:12288
    ds_read_b64_tr_b16 a[162:163], v11 offset:12800
    s_add_u32 m0, m0, 4096
    s_add_u32 s66, s66, 4096
    buffer_load_dwordx4 v2, s[28:31], s66 offen offset:0 sc1 lds
    v_mfma_f32_32x32x16_bf16 v[152:167], a[168:171], a[56:59], v[152:167]
    ds_read_b64_tr_b16 a[164:165], v12 offset:12288
    ds_read_b64_tr_b16 a[166:167], v12 offset:12800
    v_mfma_f32_32x32x16_bf16 v[168:183], a[172:175], a[56:59], v[168:183]
    ds_read_b64_tr_b16 a[168:169], v11 offset:32768
    ds_read_b64_tr_b16 a[170:171], v11 offset:33280
    buffer_load_dwordx4 v2, s[28:31], s66 offen offset:1024 sc1 lds
    s_waitcnt lgkmcnt(6)
    v_mfma_f32_32x32x16_bf16 v[120:135], a[176:179], a[60:63], v[120:135]
    ds_read_b64_tr_b16 a[172:173], v12 offset:32768
    ds_read_b64_tr_b16 a[174:175], v12 offset:33280
    v_mfma_f32_32x32x16_bf16 v[136:151], a[180:183], a[60:63], v[136:151]
    ds_read_b64_tr_b16 a[176:177], v11 offset:14336
    ds_read_b64_tr_b16 a[178:179], v11 offset:14848
    s_add_u32 s67, s50, 1
    s_and_b32 s67, s67, 3
    s_lshl_b32 s66, s47, 2
    s_add_u32 s66, s66, s67
    s_mul_i32 s66, s66, 40960
    s_mul_i32 s67, s3, 10240
    s_add_u32 s66, s66, s67
    s_branch L_padskip0
.p2align 12
L_pad0:
    s_setpc_b64 s[62:63]
L_padskip0:
    s_add_u32 s66, s66, 4194304
    s_add_u32 m0, s67, 0
    s_nop 0
    buffer_load_dwordx4 v2, s[28:31], s66 offen offset:0 sc1 lds
    v_mfma_f32_32x32x16_bf16 v[152:167], a[184:187], a[60:63], v[152:167]
    ds_read_b64_tr_b16 a[180:181], v12 offset:14336
    ds_read_b64_tr_b16 a[182:183], v12 offset:14848
    v_mfma_f32_32x32x16_bf16 v[168:183], a[188:191], a[60:63], v[168:183]
    ds_read_b64_tr_b16 a[184:185], v11 offset:34816
    ds_read_b64_tr_b16 a[186:187], v11 offset:35328
    buffer_load_dwordx4 v2, s[28:31], s66 offen offset:1024 sc1 lds
    s_waitcnt lgkmcnt(6)
    v_mfma_f32_32x32x16_bf16 v[120:135], a[160:163], a[64:67], v[120:135]
    ds_read_b64_tr_b16 a[188:189], v12 offset:34816
    ds_read_b64_tr_b16 a[190:191], v12 offset:35328
    v_mfma_f32_32x32x16_bf16 v[136:151], a[164:167], a[64:67], v[136:151]
    ds_read_b64_tr_b16 a[160:161], v11 offset:16384
    ds_read_b64_tr_b16 a[162:163], v11 offset:16896
    buffer_load_dwordx4 v2, s[28:31], s66 offen offset:2048 sc1 lds
    v_mfma_f32_32x32x16_bf16 v[152:167], a[168:171], a[64:67], v[152:167]
    ds_read_b64_tr_b16 a[164:165], v12 offset:16384
    ds_read_b64_tr_b16 a[166:167], v12 offset:16896
    v_mfma_f32_32x32x16_bf16 v[168:183], a[172:175], a[64:67], v[168:183]
    ds_read_b64_tr_b16 a[168:169], v11 offset:36864
    ds_read_b64_tr_b16 a[170:171], v11 offset:37376
    buffer_load_dwordx4 v2, s[28:31], s66 offen offset:3072 sc1 lds
    s_waitcnt lgkmcnt(6)
    v_mfma_f32_32x32x16_bf16 v[120:135], a[176:179], a[68:71], v[120:135]
    ds_read_b64_tr_b16 a[172:173], v12 offset:36864
    ds_read_b64_tr_b16 a[174:175], v12 offset:37376
    v_mfma_f32_32x32x16_bf16 v[136:151], a[180:183], a[68:71], v[136:151]
    ds_read_b64_tr_b16 a[176:177], v11 offset:18432
    ds_read_b64_tr_b16 a[178:179], v11 offset:18944
    s_add_u32 m0, m0, 4096
    s_add_u32 s66, s66, 4096
    buffer_load_dwordx4 v2, s[28:31], s66 offen offset:0 sc1 lds
    v_mfma_f32_32x32x16_bf16 v[152:167], a[184:187], a[68:71], v[152:167]
    ds_read_b64_tr_b16 a[180:181], v12 offset:18432
    ds_read_b64_tr_b16 a[182:183], v12 offset:18944
    v_mfma_f32_32x32x16_bf16 v[168:183], a[188:191], a[68:71], v[168:183]
    ds_read_b64_tr_b16 a[184:185], v11 offset:38912
    ds_read_b64_tr_b16 a[186:187], v11 offset:39424
    buffer_load_dwordx4 v2, s[28:31], s66 offen offset:1024 sc1 lds
    s_waitcnt lgkmcnt(6)
    v_mfma_f32_32x32x16_bf16 v[120:135], a[160:163], a[72:75], v[120:135]
    ds_read_b64_tr_b16 a[188:189], v12 offset:38912
    ds_read_b64_tr_b16 a[190:191], v12 offset:39424
    v_mfma_f32_32x32x16_bf16 v[136:151], a[164:167], a[72:75], v[136:151]
    buffer_load_dwordx4 v2, s[28:31], s66 offen offset:2048 sc1 lds
    v_mfma_f32_32x32x16_bf16 v[152:167], a[168:171], a[72:75], v[152:167]
    v_mfma_f32_32x32x16_bf16 v[168:183], a[172:175], a[72:75], v[168:183]
    s_waitcnt vmcnt(7)
    s_waitcnt lgkmcnt(0)
    s_barrier
    v_add_u32 v11, 81920, v2
    ds_read_b128 a[160:163], v11 offset:0
    ds_read_b128 a[164:167], v11 offset:1024
    buffer_load_dwordx4 v2, s[28:31], s66 offen offset:3072 sc1 lds
    v_mfma_f32_32x32x16_bf16 v[120:135], a[176:179], a[76:79], v[120:135]
    ds_read_b128 a[168:171], v11 offset:2048
    ds_read_b128 a[172:175], v11 offset:3072
    v_mfma_f32_32x32x16_bf16 v[136:151], a[180:183], a[76:79], v[136:151]
    ds_read_b128 a[176:179], v11 offset:4096
    s_add_u32 m0, m0, 4096
    s_add_u32 s66, s66, 4096
    buffer_load_dwordx4 v2, s[28:31], s66 offen offset:0 sc1 lds
    v_mfma_f32_32x32x16_bf16 v[152:167], a[184:187], a[76:79], v[152:167]
    ds_read_b128 a[180:183], v11 offset:5120
    v_mfma_f32_32x32x16_bf16 v[168:183], a[188:191], a[76:79], v[168:183]
    ds_read_b128 a[184:187], v11 offset:6144
    buffer_load_dwordx4 v2, s[28:31], s66 offen offset:1024 sc1 lds
    s_waitcnt lgkmcnt(3)
    v_mfma_f32_32x32x16_bf16 v[56:71], a[160:163], a[0:3], 0
    ds_read_b128 a[188:191], v11 offset:7168
    v_mfma_f32_32x32x16_bf16 v[72:87], a[164:167], a[0:3], 0
    ds_read_b128 a[160:163], v11 offset:8192
    buffer_load_dwordx4 a[92:95], v2, s[28:31], s60 offen offset:3072 sc1
    v_mfma_f32_32x32x16_bf16 v[88:103], a[168:171], a[0:3], 0
    ds_read_b128 a[164:167], v11 offset:9216
    v_mfma_f32_32x32x16_bf16 v[104:119], a[172:175], a[0:3], 0
    ds_read_b128 a[168:171], v11 offset:10240
    s_add_u32 s60, s60, 4096
    buffer_load_dwordx4 a[96:99], v2, s[28:31], s60 offen offset:0 sc1
    s_waitcnt lgkmcnt(3)
    v_mfma_f32_32x32x16_bf16 v[56:71], a[176:179], a[4:7], v[56:71]
    ds_read_b128 a[172:175], v11 offset:11264
    v_mfma_f32_32x32x16_bf16 v[72:87], a[180:183], a[4:7], v[72:87]
    ds_read_b128 a[176:179], v11 offset:12288
    buffer_load_dwordx4 a[100:103], v2, s[28:31], s60 offen offset:1024 sc1
    v_mfma_f32_32x32x16_bf16 v[88:103], a[184:187], a[4:7], v[88:103]
    ds_read_b128 a[180:183], v11 offset:13312
    v_mfma_f32_32x32x16_bf16 v[104:119], a[188:191], a[4:7], v[104:119]
    ds_read_b128 a[184:187], v11 offset:14336
    buffer_load_dwordx4 a[104:107], v2, s[28:31], s60 offen offset:2048 sc1
    s_waitcnt lgkmcnt(3)
    v_mfma_f32_32x32x16_bf16 v[56:71], a[160:163], a[8:11], v[56:71]
    ds_read_b128 a[188:191], v11 offset:15360
    v_mfma_f32_32x32x16_bf16 v[72:87], a[164:167], a[8:11], v[72:87]
    ds_read_b128 a[160:163], v11 offset:16384
    buffer_load_dwordx4 a[108:111], v2, s[28:31], s60 offen offset:3072 sc1
    v_mfma_f32_32x32x16_bf16 v[88:103], a[168:171], a[8:11], v[88:103]
    ds_read_b128 a[164:167], v11 offset:17408
    v_mfma_f32_32x32x16_bf16 v[104:119], a[172:175], a[8:11], v[104:119]
    ds_read_b128 a[168:171], v11 offset:18432
    s_add_u32 s60, s60, 4096
    buffer_load_dwordx4 a[112:115], v2, s[28:31], s60 offen offset:0 sc1
    s_waitcnt lgkmcnt(3)
    v_mfma_f32_32x32x16_bf16 v[56:71], a[176:179], a[12:15], v[56:71]
    ds_read_b128 a[172:175], v11 offset:19456
    v_mfma_f32_32x32x16_bf16 v[72:87], a[180:183], a[12:15], v[72:87]
    ds_read_b128 a[176:179], v11 offset:20480
    buffer_load_dwordx4 a[116:119], v2, s[28:31], s60 offen offset:1024 sc1
    v_mfma_f32_32x32x16_bf16 v[88:103], a[184:187], a[12:15], v[88:103]
    ds_read_b128 a[180:183], v11 offset:21504
    v_mfma_f32_32x32x16_bf16 v[104:119], a[188:191], a[12:15], v[104:119]
    ds_read_b128 a[184:187], v11 offset:22528
    s_lshl_b32 s97, s3, 12
    s_add_u32 m0, s97, 122880
    s_nop 0
    buffer_load_dwordx4 v184, s[40:43], 0 offen lds
    s_waitcnt lgkmcnt(3)
    v_mfma_f32_32x32x16_bf16 v[56:71], a[160:163], a[16:19], v[56:71]
    ds_read_b128 a[188:191], v11 offset:23552
    v_mfma_f32_32x32x16_bf16 v[72:87], a[164:167], a[16:19], v[72:87]
    ds_read_b128 a[160:163], v11 offset:24576
    s_lshl_b32 s97, s3, 12
    s_add_u32 m0, s97, 123904
    s_nop 0
    buffer_load_dwordx4 v185, s[40:43], 0 offen lds
    v_mfma_f32_32x32x16_bf16 v[88:103], a[168:171], a[16:19], v[88:103]
    ds_read_b128 a[164:167], v11 offset:25600
    v_mfma_f32_32x32x16_bf16 v[104:119], a[172:175], a[16:19], v[104:119]
    ds_read_b128 a[168:171], v11 offset:26624
    s_lshl_b32 s97, s3, 12
    s_add_u32 m0, s97, 124928
    s_nop 0
    buffer_load_dwordx4 v186, s[40:43], 0 offen lds
    s_waitcnt lgkmcnt(3)
    v_mfma_f32_32x32x16_bf16 v[56:71], a[176:179], a[20:23], v[56:71]
    ds_read_b128 a[172:175], v11 offset:27648
    v_mfma_f32_32x32x16_bf16 v[72:87], a[180:183], a[20:23], v[72:87]
    ds_read_b128 a[176:179], v11 offset:28672
    s_lshl_b32 s97, s3, 12
    s_add_u32 m0, s97, 125952
    s_nop 0
    buffer_load_dwordx4 v187, s[40:43], 0 offen lds
    v_mfma_f32_32x32x16_bf16 v[88:103], a[184:187], a[20:23], v[88:103]
    ds_read_b128 a[180:183], v11 offset:29696
    v_mfma_f32_32x32x16_bf16 v[104:119], a[188:191], a[20:23], v[104:119]
    ds_read_b128 a[184:187], v11 offset:30720
    s_add_u32 s67, s50, 2
    s_and_b32 s67, s67, 3
    s_lshl_b32 s66, s47, 2
    s_add_u32 s66, s66, s67
    s_mul_i32 s66, s66, 40960
    s_mul_i32 s67, s3, 10240
    s_add_u32 s66, s66, s67
    s_add_u32 s66, s66, 4194304
    s_add_u32 m0, s67, 40960
    s_nop 0
    buffer_load_dwordx4 v2, s[28:31], s66 offen offset:0 sc1 lds
    s_waitcnt lgkmcnt(3)
    v_mfma_f32_32x32x16_bf16 v[56:71], a[160:163], a[24:27], v[56:71]
    ds_read_b128 a[188:191], v11 offset:31744
    v_mfma_f32_32x32x16_bf16 v[72:87], a[164:167], a[24:27], v[72:87]
    ds_read_b128 a[160:163], v11 offset:32768
    buffer_load_dwordx4 v2, s[28:31], s66 offen offset:1024 sc1 lds
    v_mfma_f32_32x32x16_bf16 v[88:103], a[168:171], a[24:27], v[88:103]
    ds_read_b128 a[164:167], v11 offset:33792
    v_mfma_f32_32x32x16_bf16 v[104:119], a[172:175], a[24:27], v[104:119]
    ds_read_b128 a[168:171], v11 offset:34816
    buffer_load_dwordx4 v2, s[28:31], s66 offen offset:2048 sc1 lds
    s_waitcnt lgkmcnt(3)
    v_mfma_f32_32x32x16_bf16 v[56:71], a[176:179], a[28:31], v[56:71]
    ds_read_b128 a[172:175], v11 offset:35840
    v_mfma_f32_32x32x16_bf16 v[72:87], a[180:183], a[28:31], v[72:87]
    ds_read_b128 a[176:179], v11 offset:36864
    buffer_load_dwordx4 v2, s[28:31], s66 offen offset:3072 sc1 lds
    v_mfma_f32_32x32x16_bf16 v[88:103], a[184:187], a[28:31], v[88:103]
    ds_read_b128 a[180:183], v11 offset:37888
    v_mfma_f32_32x32x16_bf16 v[104:119], a[188:191], a[28:31], v[104:119]
    ds_read_b128 a[184:187], v11 offset:38912
    s_add_u32 m0, m0, 4096
    s_add_u32 s66, s66, 4096
    buffer_load_dwordx4 v2, s[28:31], s66 offen offset:0 sc1 lds
    s_waitcnt lgkmcnt(3)
    v_mfma_f32_32x32x16_bf16 v[56:71], a[160:163], a[32:35], v[56:71]
    ds_read_b128 a[188:191], v11 offset:39936
    v_mfma_f32_32x32x16_bf16 v[72:87], a[164:167], a[32:35], v[72:87]
    buffer_load_dwordx4 v2, s[28:31], s66 offen offset:1024 sc1 lds
    v_mfma_f32_32x32x16_bf16 v[88:103], a[168:171], a[32:35], v[88:103]
    v_mfma_f32_32x32x16_bf16 v[104:119], a[172:175], a[32:35], v[104:119]
    s_waitcnt vmcnt(17)
    s_waitcnt lgkmcnt(0)
    s_barrier
    v_add_u32 v11, 0, v2
    ds_read_b128 a[160:163], v11 offset:0
    ds_read_b128 a[164:167], v11 offset:1024
    buffer_load_dwordx4 v2, s[28:31], s66 offen offset:2048 sc1 lds
    v_mfma_f32_32x32x16_bf16 v[56:71], a[176:179], a[36:39], v[56:71]
    ds_read_b128 a[168:171], v11 offset:2048
    ds_read_b128 a[172:175], v11 offset:3072
    v_mfma_f32_32x32x16_bf16 v[72:87], a[180:183], a[36:39], v[72:87]
    ds_read_b128 a[176:179], v11 offset:4096
    buffer_load_dwordx4 v2, s[28:31], s66 offen offset:3072 sc1 lds
    v_mfma_f32_32x32x16_bf16 v[88:103], a[184:187], a[36:39], v[88:103]
    ds_read_b128 a[180:183], v11 offset:5120
    v_mfma_f32_32x32x16_bf16 v[104:119], a[188:191], a[36:39], v[104:119]
    ds_read_b128 a[184:187], v11 offset:6144
    s_add_u32 m0, m0, 4096
    s_add_u32 s66, s66, 4096
    buffer_load_dwordx4 v2, s[28:31], s66 offen offset:0 sc1 lds
    s_waitcnt lgkmcnt(3)
    v_mfma_f32_32x32x16_bf16 v[56:71], a[160:163], a[40:43], v[56:71]
    ds_read_b128 a[188:191], v11 offset:7168
    v_mfma_f32_32x32x16_bf16 v[72:87], a[164:167], a[40:43], v[72:87]
    ds_read_b128 a[160:163], v11 offset:8192
    buffer_load_dwordx4 v2, s[28:31], s66 offen offset:1024 sc1 lds
    v_mfma_f32_32x32x16_bf16 v[88:103], a[168:171], a[40:43], v[88:103]
    ds_read_b128 a[164:167], v11 offset:9216
    v_mfma_f32_32x32x16_bf16 v[104:119], a[172:175], a[40:43], v[104:119]
    ds_read_b128 a[168:171], v11 offset:10240
    s_add_u32 s59, s50, 3
    s_and_b32 s59, s59, 3
    s_mul_i32 s59, s59, 10240
    s_add_u32 s60, s83, s59
    buffer_load_dwordx4 a[120:123], v2, s[28:31], s60 offen offset:0 sc1
    s_waitcnt lgkmcnt(3)
    v_mfma_f32_32x32x16_bf16 v[56:71], a[176:179], a[44:47], v[56:71]
    ds_read_b128 a[172:175], v11 offset:11264
    v_mfma_f32_32x32x16_bf16 v[72:87], a[180:183], a[44:47], v[72:87]
    ds_read_b128 a[176:179], v11 offset:12288
    buffer_load_dwordx4 a[124:127], v2, s[28:31], s60 offen offset:1024 sc1
    v_mfma_f32_32x32x16_bf16 v[88:103], a[184:187], a[44:47], v[88:103]
    ds_read_b128 a[180:183], v11 offset:13312
    v_mfma_f32_32x32x16_bf16 v[104:119], a[188:191], a[44:47], v[104:119]
    ds_read_b128 a[184:187], v11 offset:14336
    buffer_load_dwordx4 a[128:131], v2, s[28:31], s60 offen offset:2048 sc1
    s_waitcnt lgkmcnt(3)
    v_mfma_f32_32x32x16_bf16 v[56:71], a[160:163], a[48:51], v[56:71]
    ds_read_b128 a[188:191], v11 offset:15360
    v_mfma_f32_32x32x16_bf16 v[72:87], a[164:167], a[48:51], v[72:87]
    ds_read_b128 a[160:163], v11 offset:16384
    buffer_load_dwordx4 a[132:135], v2, s[28:31], s60 offen offset:3072 sc1
    v_mfma_f32_32x32x16_bf16 v[88:103], a[168:171], a[48:51], v[88:103]
    ds_read_b128 a[164:167], v11 offset:17408
    v_mfma_f32_32x32x16_bf16 v[104:119], a[172:175], a[48:51], v[104:119]
    ds_read_b128 a[168:171], v11 offset:18432
    s_add_u32 s60, s60, 4096
    buffer_load_dwordx4 a[136:139], v2, s[28:31], s60 offen offset:0 sc1
    s_waitcnt lgkmcnt(3)
    v_mfma_f32_32x32x16_bf16 v[56:71], a[176:179], a[52:55], v[56:71]
    ds_read_b128 a[172:175], v11 offset:19456
    v_mfma_f32_32x32x16_bf16 v[72:87], a[180:183], a[52:55], v[72:87]
    ds_read_b128 a[176:179], v11 offset:20480
    buffer_load_dwordx4 a[140:143], v2, s[28:31], s60 offen offset:1024 sc1
    v_mfma_f32_32x32x16_bf16 v[88:103], a[184:187], a[52:55], v[88:103]
    ds_read_b128 a[180:183], v11 offset:21504
    v_mfma_f32_32x32x16_bf16 v[104:119], a[188:191], a[52:55], v[104:119]
    ds_read_b128 a[184:187], v11 offset:22528
    buffer_load_dwordx4 a[144:147], v2, s[28:31], s60 offen offset:2048 sc1
    s_waitcnt lgkmcnt(3)
    v_mfma_f32_32x32x16_bf16 v[56:71], a[160:163], a[56:59], v[56:71]
    ds_read_b128 a[188:191], v11 offset:23552
    v_mfma_f32_32x32x16_bf16 v[72:87], a[164:167], a[56:59], v[72:87]
    ds_read_b128 a[160:163], v11 offset:24576
    buffer_load_dwordx4 a[148:151], v2, s[28:31], s60 offen offset:3072 sc1
    v_mfma_f32_32x32x16_bf16 v[88:103], a[168:171], a[56:59], v[88:103]
    ds_read_b128 a[164:167], v11 offset:25600
    v_mfma_f32_32x32x16_bf16 v[104:119], a[172:175], a[56:59], v[104:119]
    ds_read_b128 a[168:171], v11 offset:26624
    s_add_u32 s60, s60, 4096
    buffer_load_dwordx4 a[152:155], v2, s[28:31], s60 offen offset:0 sc1
    s_waitcnt lgkmcnt(3)
    v_mfma_f32_32x32x16_bf16 v[56:71], a[176:179], a[60:63], v[56:71]
    ds_read_b128 a[172:175], v11 offset:27648
    v_mfma_f32_32x32x16_bf16 v[72:87], a[180:183], a[60:63], v[72:87]
    ds_read_b128 a[176:179], v11 offset:28672
    buffer_load_dwordx4 a[156:159], v2, s[28:31], s60 offen offset:1024 sc1
    v_mfma_f32_32x32x16_bf16 v[88:103], a[184:187], a[60:63], v[88:103]
    ds_read_b128 a[180:183], v11 offset:29696
    v_mfma_f32_32x32x16_bf16 v[104:119], a[188:191], a[60:63], v[104:119]
    ds_read_b128 a[184:187], v11 offset:30720
    s_add_u32 s67, s50, 3
    s_and_b32 s67, s67, 3
    s_lshl_b32 s66, s47, 2
    s_add_u32 s66, s66, s67
    s_mul_i32 s66, s66, 40960
    s_mul_i32 s67, s3, 10240
    s_add_u32 s66, s66, s67
    s_add_u32 s66, s66, 4194304
    s_add_u32 m0, s67, 81920
    s_nop 0
    buffer_load_dwordx4 v2, s[28:31], s66 offen offset:0 sc1 lds
    s_waitcnt lgkmcnt(3)
    v_mfma_f32_32x32x16_bf16 v[56:71], a[160:163], a[64:67], v[56:71]
    ds_read_b128 a[188:191], v11 offset:31744
    v_mfma_f32_32x32x16_bf16 v[72:87], a[164:167], a[64:67], v[72:87]
    ds_read_b128 a[160:163], v11 offset:32768
    buffer_load_dwordx4 v2, s[28:31], s66 offen offset:1024 sc1 lds
    v_mfma_f32_32x32x16_bf16 v[88:103], a[168:171], a[64:67], v[88:103]
    ds_read_b128 a[164:167], v11 offset:33792
    v_mfma_f32_32x32x16_bf16 v[104:119], a[172:175], a[64:67], v[104:119]
    ds_read_b128 a[168:171], v11 offset:34816
    buffer_load_dwordx4 v2, s[28:31], s66 offen offset:2048 sc1 lds
    s_waitcnt lgkmcnt(3)
    v_mfma_f32_32x32x16_bf16 v[56:71], a[176:179], a[68:71], v[56:71]
    ds_read_b128 a[172:175], v11 offset:35840
    v_mfma_f32_32x32x16_bf16 v[72:87], a[180:183], a[68:71], v[72:87]
    ds_read_b128 a[176:179], v11 offset:36864
    buffer_load_dwordx4 v2, s[28:31], s66 offen offset:3072 sc1 lds
    v_mfma_f32_32x32x16_bf16 v[88:103], a[184:187], a[68:71], v[88:103]
    ds_read_b128 a[180:183], v11 offset:37888
    s_waitcnt vmcnt(24)
    ds_read_b64_tr_b16 v[32:33], v188 offset:0
    ds_read_b64_tr_b16 v[34:35], v188 offset:512
    ds_read_b64_tr_b16 v[36:37], v188 offset:32
    ds_read_b64_tr_b16 v[38:39], v188 offset:544
    v_mfma_f32_32x32x16_bf16 v[104:119], a[188:191], a[68:71], v[104:119]
    ds_read_b128 a[184:187], v11 offset:38912
    s_add_u32 m0, m0, 4096
    s_add_u32 s66, s66, 4096
    buffer_load_dwordx4 v2, s[28:31], s66 offen offset:0 sc1 lds
    ds_read_b64_tr_b16 v[40:41], v188 offset:64
    ds_read_b64_tr_b16 v[42:43], v188 offset:576
    s_waitcnt lgkmcnt(9)
    v_mfma_f32_32x32x16_bf16 v[56:71], a[160:163], a[72:75], v[56:71]
    ds_read_b128 a[188:191], v11 offset:39936
    ds_read_b64_tr_b16 v[44:45], v188 offset:96
    ds_read_b64_tr_b16 v[46:47], v188 offset:608
    v_mfma_f32_32x32x16_bf16 v[72:87], a[164:167], a[72:75], v[72:87]
    buffer_load_dwordx4 v2, s[28:31], s66 offen offset:1024 sc1 lds
    v_mfma_f32_32x32x16_bf16 v[88:103], a[168:171], a[72:75], v[88:103]
    v_mfma_f32_32x32x16_bf16 v[104:119], a[172:175], a[72:75], v[104:119]
    s_waitcnt vmcnt(16)
    s_waitcnt lgkmcnt(0)
    s_barrier
    v_add_u32 v11, 40960, v2
    ds_read_b128 a[160:163], v11 offset:0
    ds_read_b128 a[164:167], v11 offset:1024
    buffer_load_dwordx4 v2, s[28:31], s66 offen offset:2048 sc1 lds
    v_mfma_f32_32x32x16_bf16 v[56:71], a[176:179], a[76:79], v[56:71]
    ds_read_b128 a[168:171], v11 offset:2048
    ds_read_b128 a[172:175], v11 offset:3072
    v_mfma_f32_32x32x16_bf16 v[72:87], a[180:183], a[76:79], v[72:87]
    ds_read_b128 a[176:179], v11 offset:4096
    buffer_load_dwordx4 v2, s[28:31], s66 offen offset:3072 sc1 lds
    buffer_store_dwordx4 v[32:35], v189, s[28:31], s98 offen sc1
    v_mfma_f32_32x32x16_bf16 v[88:103], a[184:187], a[76:79], v[88:103]
    ds_read_b128 a[180:183], v11 offset:5120
    v_mfma_f32_32x32x16_bf16 v[104:119], a[188:191], a[76:79], v[104:119]
    ds_read_b128 a[184:187], v11 offset:6144
    s_add_u32 m0, m0, 4096
    s_add_u32 s66, s66, 4096
    buffer_load_dwordx4 v2, s[28:31], s66 offen offset:0 sc1 lds
    s_waitcnt lgkmcnt(3)
    v_mfma_f32_32x32x16_bf16 v[56:71], a[160:163], a[80:83], v[56:71]
    ds_read_b128 a[188:191], v11 offset:7168
    v_mfma_f32_32x32x16_bf16 v[72:87], a[164:167], a[80:83], v[72:87]
    ds_read_b128 a[160:163], v11 offset:8192
    buffer_load_dwordx4 v2, s[28:31], s66 offen offset:1024 sc1 lds
    v_mfma_f32_32x32x16_bf16 v[88:103], a[168:171], a[80:83], v[88:103]
    ds_read_b128 a[164:167], v11 offset:9216
    buffer_store_dwordx4 v[36:39], v189, s[28:31], s99 offen sc1
    v_mfma_f32_32x32x16_bf16 v[104:119], a[172:175], a[80:83], v[104:119]
    ds_read_b128 a[168:171], v11 offset:10240
    s_waitcnt lgkmcnt(3)
    v_mfma_f32_32x32x16_bf16 v[56:71], a[176:179], a[84:87], v[56:71]
    ds_read_b128 a[172:175], v11 offset:11264
    s_add_u32 s66, s50, 2
    s_and_b32 s66, s66, 3
    s_lshl_b32 s66, s66, 2
    s_add_u32 s66, s66, s3
    s_mul_i32 s66, s66, 122880
    s_mul_i32 s67, s3, 5120
    s_add_u32 m0, s67, 0
    s_nop 0
    buffer_load_dwordx4 v7, s[12:15], s66 offen lds
    v_mfma_f32_32x32x16_bf16 v[72:87], a[180:183], a[84:87], v[72:87]
    ds_read_b128 a[176:179], v11 offset:12288
    buffer_store_dwordx4 v[40:43], v189, s[28:31], s100 offen sc1
    v_mfma_f32_32x32x16_bf16 v[88:103], a[184:187], a[84:87], v[88:103]
    ds_read_b128 a[180:183], v11 offset:13312
    v_mfma_f32_32x32x16_bf16 v[104:119], a[188:191], a[84:87], v[104:119]
    ds_read_b128 a[184:187], v11 offset:14336
    s_add_u32 m0, m0, 20480
    s_nop 0
    buffer_load_dwordx4 v7, s[16:19], s66 offen lds
    s_waitcnt lgkmcnt(3)
    v_mfma_f32_32x32x16_bf16 v[56:71], a[160:163], a[88:91], v[56:71]
    ds_read_b128 a[188:191], v11 offset:15360
    v_mfma_f32_32x32x16_bf16 v[72:87], a[164:167], a[88:91], v[72:87]
    ds_read_b128 a[160:163], v11 offset:16384
    s_add_u32 m0, m0, 4294947840
    s_add_u32 s66, s66, 24576
    buffer_load_dwordx4 v7, s[12:15], s66 offen lds
    v_mfma_f32_32x32x16_bf16 v[88:103], a[168:171], a[88:91], v[88:103]
    ds_read_b128 a[164:167], v11 offset:17408
    buffer_store_dwordx4 v[44:47], v189, s[28:31], s101 offen sc1
    v_mfma_f32_32x32x16_bf16 v[104:119], a[172:175], a[88:91], v[104:119]
    ds_read_b128 a[168:171], v11 offset:18432
    s_waitcnt lgkmcnt(3)
    v_mfma_f32_32x32x16_bf16 v[56:71], a[176:179], a[92:95], v[56:71]
    ds_read_b128 a[172:175], v11 offset:19456
    s_add_u32 m0, m0, 20480
    s_nop 0
    buffer_load_dwordx4 v7, s[16:19], s66 offen lds
    v_mfma_f32_32x32x16_bf16 v[72:87], a[180:183], a[92:95], v[72:87]
    ds_read_b128 a[176:179], v11 offset:20480
    v_mfma_f32_32x32x16_bf16 v[88:103], a[184:187], a[92:95], v[88:103]
    ds_read_b128 a[180:183], v11 offset:21504
    s_add_u32 m0, m0, 4294947840
    s_add_u32 s66, s66, 24576
    buffer_load_dwordx4 v7, s[12:15], s66 offen lds
    v_mfma_f32_32x32x16_bf16 v[104:119], a[188:191], a[92:95], v[104:119]
    ds_read_b128 a[184:187], v11 offset:22528
    s_waitcnt lgkmcnt(3)
    v_mfma_f32_32x32x16_bf16 v[56:71], a[160:163], a[96:99], v[56:71]
    ds_read_b128 a[188:191], v11 offset:23552
    s_add_u32 m0, m0, 20480
    s_nop 0
    buffer_load_dwordx4 v7, s[16:19], s66 offen lds
    v_mfma_f32_32x32x16_bf16 v[72:87], a[164:167], a[96:99], v[72:87]
    ds_read_b128 a[160:163], v11 offset:24576
    v_mfma_f32_32x32x16_bf16 v[88:103], a[168:171], a[96:99], v[88:103]
    ds_read_b128 a[164:167], v11 offset:25600
    s_add_u32 m0, m0, 4294947840
    s_add_u32 s66, s66, 24576
    buffer_load_dwordx4 v7, s[12:15], s66 offen lds
    v_mfma_f32_32x32x16_bf16 v[104:119], a[172:175], a[96:99], v[104:119]
    ds_read_b128 a[168:171], v11 offset:26624
    s_waitcnt lgkmcnt(3)
    v_mfma_f32_32x32x16_bf16 v[56:71], a[176:179], a[100:103], v[56:71]
    ds_read_b128 a[172:175], v11 offset:27648
    s_add_u32 m0, m0, 20480
    s_nop 0
    buffer_load_dwordx4 v7, s[16:19], s66 offen lds
    v_mfma_f32_32x32x16_bf16 v[72:87], a[180:183], a[100:103], v[72:87]
    ds_read_b128 a[176:179], v11 offset:28672
    v_mfma_f32_32x32x16_bf16 v[88:103], a[184:187], a[100:103], v[88:103]
    ds_read_b128 a[180:183], v11 offset:29696
    s_add_u32 m0, m0, 4294947840
    s_add_u32 s66, s66, 24576
    buffer_load_dwordx4 v7, s[12:15], s66 offen lds
    v_mfma_f32_32x32x16_bf16 v[104:119], a[188:191], a[100:103], v[104:119]
    ds_read_b128 a[184:187], v11 offset:30720
    s_waitcnt lgkmcnt(3)
    v_mfma_f32_32x32x16_bf16 v[56:71], a[160:163], a[104:107], v[56:71]
    ds_read_b128 a[188:191], v11 offset:31744
    s_add_u32 m0, m0, 20480
    s_nop 0
    buffer_load_dwordx4 v7, s[16:19], s66 offen lds
    v_mfma_f32_32x32x16_bf16 v[72:87], a[164:167], a[104:107], v[72:87]
    ds_read_b128 a[160:163], v11 offset:32768
    v_mfma_f32_32x32x16_bf16 v[88:103], a[168:171], a[104:107], v[88:103]
    ds_read_b128 a[164:167], v11 offset:33792
    v_mfma_f32_32x32x16_bf16 v[104:119], a[172:175], a[104:107], v[104:119]
    ds_read_b128 a[168:171], v11 offset:34816
    s_waitcnt lgkmcnt(3)
    v_mfma_f32_32x32x16_bf16 v[56:71], a[176:179], a[108:111], v[56:71]
    ds_read_b128 a[172:175], v11 offset:35840
    v_mfma_f32_32x32x16_bf16 v[72:87], a[180:183], a[108:111], v[72:87]
    ds_read_b128 a[176:179], v11 offset:36864
    v_mfma_f32_32x32x16_bf16 v[88:103], a[184:187], a[108:111], v[88:103]
    ds_read_b128 a[180:183], v11 offset:37888
    v_mfma_f32_32x32x16_bf16 v[104:119], a[188:191], a[108:111], v[104:119]
    ds_read_b128 a[184:187], v11 offset:38912
    s_waitcnt lgkmcnt(3)
    v_mfma_f32_32x32x16_bf16 v[56:71], a[160:163], a[112:115], v[56:71]
    ds_read_b128 a[188:191], v11 offset:39936
    v_mfma_f32_32x32x16_bf16 v[72:87], a[164:167], a[112:115], v[72:87]
    v_mfma_f32_32x32x16_bf16 v[88:103], a[168:171], a[112:115], v[88:103]
    v_mfma_f32_32x32x16_bf16 v[104:119], a[172:175], a[112:115], v[104:119]
    s_waitcnt vmcnt(13)
    s_waitcnt lgkmcnt(0)
    s_barrier
    v_add_u32 v11, 81920, v2
    s_waitcnt vmcnt(7)
    s_lshl_b32 s63, s2, 7
    s_lshl_b32 s62, s3, 3
    s_add_u32 s63, s63, s62
    s_add_u32 s63, s63, 69632
    buffer_store_dwordx2 v[4:5], v3, s[28:31], s63 offen sc1
    ds_read_b128 a[160:163], v11 offset:0
    ds_read_b128 a[164:167], v11 offset:4096
    s_add_u32 s66, s50, 3
    s_and_b32 s66, s66, 3
    s_lshl_b32 s66, s66, 2
    s_add_u32 s66, s66, s3
    s_mul_i32 s66, s66, 122880
    s_mul_i32 s67, s3, 5120
    s_add_u32 m0, s67, 40960
    s_nop 0
    buffer_load_dwordx4 v7, s[12:15], s66 offen lds
    v_mfma_f32_32x32x16_bf16 v[56:71], a[176:179], a[116:119], v[56:71]
    ds_read_b128 a[168:171], v11 offset:8192
    ds_read_b128 a[172:175], v11 offset:12288
    v_mfma_f32_32x32x16_bf16 v[72:87], a[180:183], a[116:119], v[72:87]
    ds_read_b128 a[176:179], v11 offset:16384
    s_add_u32 m0, m0, 20480
    s_nop 0
    buffer_load_dwordx4 v7, s[16:19], s66 offen lds
    v_mfma_f32_32x32x16_bf16 v[88:103], a[184:187], a[116:119], v[88:103]
    ds_read_b128 a[180:183], v11 offset:20480
    v_mfma_f32_32x32x16_bf16 v[104:119], a[188:191], a[116:119], v[104:119]
    ds_read_b128 a[184:187], v11 offset:24576
    s_add_u32 m0, m0, 4294947840
    s_add_u32 s66, s66, 24576
    buffer_load_dwordx4 v7, s[12:15], s66 offen lds
    s_waitcnt lgkmcnt(3)
    v_mfma_f32_32x32x16_bf16 v[56:71], a[160:163], a[120:123], v[56:71]
    ds_read_b128 a[188:191], v11 offset:28672
    v_min_u32 v248, 33, v1
    v_lshrrev_b32 v249, 1, v248
    v_and_b32 v248, 1, v248
    s_mul_i32 s52, s3, 12
    s_mul_i32 s53, s3, 5
    v_mfma_f32_32x32x16_bf16 v[56:71], a[164:167], a[124:127], v[56:71]
    ds_read_b128 a[160:163], v11 offset:32768
    s_add_u32 s53, s53, 36
    v_mov_b32 v250, s52
    v_mov_b32 v251, s53
    v_cmp_gt_u32 vcc, 12, v249
    s_nop 1
    v_cndmask_b32 v250, v251, v250, vcc
    v_mfma_f32_32x32x16_bf16 v[56:71], a[168:171], a[128:131], v[56:71]
    ds_read_b128 a[164:167], v11 offset:36864
    s_add_u32 m0, m0, 20480
    s_nop 0
    buffer_load_dwordx4 v7, s[16:19], s66 offen lds
    v_add_u32 v249, v249, v250
    s_mul_i32 s52, s49, 5
    s_lshr_b32 s52, s52, 2
    v_mfma_f32_32x32x16_bf16 v[56:71], a[172:175], a[132:135], v[56:71]
    ds_read_b128 a[168:171], v11 offset:1024
    v_mul_u32_u24 v249, 10, v249
    v_add3_u32 v249, v249, v248, s52
    v_lshrrev_b32 v250, 2, v249
    v_lshlrev_b32 v250, 7, v250
    v_and_b32 v249, 3, v249
    s_waitcnt lgkmcnt(3)
    v_mfma_f32_32x32x16_bf16 v[56:71], a[176:179], a[136:139], v[56:71]
    ds_read_b128 a[172:175], v11 offset:5120
    v_lshl_add_u32 v14, v249, 3, v250
    s_mov_b32 s65, 69632
    v_mfma_f32_32x32x16_bf16 v[56:71], a[180:183], a[140:143], v[56:71]
    ds_read_b128 a[176:179], v11 offset:9216
    s_add_u32 m0, m0, 4294947840
    s_add_u32 s66, s66, 24576
    buffer_load_dwordx4 v7, s[12:15], s66 offen lds
    v_mfma_f32_32x32x16_bf16 v[56:71], a[184:187], a[144:147], v[56:71]
    ds_read_b128 a[180:183], v11 offset:13312
    v_mfma_f32_32x32x16_bf16 v[56:71], a[188:191], a[148:151], v[56:71]
    ds_read_b128 a[184:187], v11 offset:17408
    s_waitcnt lgkmcnt(3)
    v_mfma_f32_32x32x16_bf16 v[56:71], a[160:163], a[152:155], v[56:71]
    ds_read_b128 a[188:191], v11 offset:21504
    s_add_u32 m0, m0, 20480
    s_nop 0
    buffer_load_dwordx4 v7, s[16:19], s66 offen lds
    v_mfma_f32_32x32x16_bf16 v[56:71], a[164:167], a[156:159], v[56:71]
    ds_read_b128 a[160:163], v11 offset:25600
    v_mfma_f32_32x32x16_bf16 v[72:87], a[168:171], a[120:123], v[72:87]
    ds_read_b128 a[164:167], v11 offset:29696
    v_mfma_f32_32x32x16_bf16 v[72:87], a[172:175], a[124:127], v[72:87]
    ds_read_b128 a[168:171], v11 offset:33792
    s_add_u32 m0, m0, 4294947840
    s_branch L_padskip1
.p2align 12
L_pad1:
    s_setpc_b64 s[62:63]
L_padskip1:
    s_add_u32 s66, s66, 24576
    buffer_load_dwordx4 v7, s[12:15], s66 offen lds
    s_waitcnt lgkmcnt(3)
    v_mfma_f32_32x32x16_bf16 v[72:87], a[176:179], a[128:131], v[72:87]
    ds_read_b128 a[172:175], v11 offset:37888
    v_mfma_f32_32x32x16_bf16 v[72:87], a[180:183], a[132:135], v[72:87]
    ds_read_b128 a[176:179], v11 offset:2048
    v_mfma_f32_32x32x16_bf16 v[72:87], a[184:187], a[136:139], v[72:87]
    ds_read_b128 a[180:183], v11 offset:6144
    s_add_u32 m0, m0, 20480
    s_nop 0
    buffer_load_dwordx4 v7, s[16:19], s66 offen lds
    v_mfma_f32_32x32x16_bf16 v[72:87], a[188:191], a[140:143], v[72:87]
    ds_read_b128 a[184:187], v11 offset:10240
    s_waitcnt lgkmcnt(3)
    v_mfma_f32_32x32x16_bf16 v[72:87], a[160:163], a[144:147], v[72:87]
    ds_read_b128 a[188:191], v11 offset:14336
    v_mfma_f32_32x32x16_bf16 v[72:87], a[164:167], a[148:151], v[72:87]
    ds_read_b128 a[160:163], v11 offset:18432
    s_add_u32 m0, m0, 4294947840
    s_add_u32 s66, s66, 24576
    buffer_load_dwordx4 v7, s[12:15], s66 offen lds
    v_mfma_f32_32x32x16_bf16 v[72:87], a[168:171], a[152:155], v[72:87]
    ds_read_b128 a[164:167], v11 offset:22528
    v_mfma_f32_32x32x16_bf16 v[72:87], a[172:175], a[156:159], v[72:87]
    ds_read_b128 a[168:171], v11 offset:26624
    s_waitcnt lgkmcnt(3)
    v_mfma_f32_32x32x16_bf16 v[88:103], a[176:179], a[120:123], v[88:103]
    ds_read_b128 a[172:175], v11 offset:30720
    s_add_u32 m0, m0, 20480
    s_nop 0
    buffer_load_dwordx4 v7, s[16:19], s66 offen lds
    v_mfma_f32_32x32x16_bf16 v[88:103], a[180:183], a[124:127], v[88:103]
    ds_read_b128 a[176:179], v11 offset:34816
    v_mfma_f32_32x32x16_bf16 v[88:103], a[184:187], a[128:131], v[88:103]
    ds_read_b128 a[180:183], v11 offset:38912
    v_cvt_pk_bf16_f32 v184, v56, v57
    v_cvt_pk_bf16_f32 v185, v58, v59
    v_cvt_pk_bf16_f32 v186, v60, v61
    v_cvt_pk_bf16_f32 v187, v62, v63
    v_cvt_pk_bf16_f32 v188, v64, v65
    v_mfma_f32_32x32x16_bf16 v[88:103], a[188:191], a[132:135], v[88:103]
    ds_read_b128 a[184:187], v11 offset:3072
    v_cvt_pk_bf16_f32 v189, v66, v67
    v_cvt_pk_bf16_f32 v190, v68, v69
    v_cvt_pk_bf16_f32 v191, v70, v71
    v_cvt_pk_bf16_f32 v192, v72, v73
    v_cvt_pk_bf16_f32 v193, v74, v75
    s_waitcnt lgkmcnt(3)
    v_mfma_f32_32x32x16_bf16 v[88:103], a[160:163], a[136:139], v[88:103]
    ds_read_b128 a[188:191], v11 offset:7168
    v_mov_b32 v194, 0
    v_mov_b32 v195, 0
    v_cvt_pk_bf16_f32 v196, v76, v77
    v_cvt_pk_bf16_f32 v197, v78, v79
    v_cvt_pk_bf16_f32 v198, v80, v81
    v_mfma_f32_32x32x16_bf16 v[88:103], a[164:167], a[140:143], v[88:103]
    ds_read_b128 a[160:163], v11 offset:11264
    v_cvt_pk_bf16_f32 v199, v82, v83
    v_cvt_pk_bf16_f32 v200, v84, v85
    v_cvt_pk_bf16_f32 v201, v86, v87
    v_mfma_f32_32x32x16_bf16 v[56:71], a[192:195], v[184:187], 0
    v_mfma_f32_32x32x16_bf16 v[88:103], a[168:171], a[144:147], v[88:103]
    ds_read_b128 a[164:167], v11 offset:15360
    v_mfma_f32_32x32x16_bf16 v[56:71], a[196:199], v[188:191], v[56:71]
    v_mfma_f32_32x32x16_bf16 v[56:71], a[200:203], v[192:195], v[56:71]
    v_mfma_f32_32x32x16_bf16 v[72:87], a[204:207], v[184:187], 0
    v_mfma_f32_32x32x16_bf16 v[88:103], a[172:175], a[148:151], v[88:103]
    ds_read_b128 a[168:171], v11 offset:19456
    v_mfma_f32_32x32x16_bf16 v[72:87], a[208:211], v[188:191], v[72:87]
    v_mfma_f32_32x32x16_bf16 v[72:87], a[212:215], v[192:195], v[72:87]
    s_waitcnt lgkmcnt(3)
    v_mfma_f32_32x32x16_bf16 v[88:103], a[176:179], a[152:155], v[88:103]
    ds_read_b128 a[172:175], v11 offset:23552
    v_mfma_f32_32x32x16_bf16 v[88:103], a[180:183], a[156:159], v[88:103]
    ds_read_b128 a[176:179], v11 offset:27648
    v_mfma_f32_32x32x16_bf16 v[104:119], a[184:187], a[120:123], v[104:119]
    ds_read_b128 a[180:183], v11 offset:31744
    v_mfma_f32_32x32x16_bf16 v[104:119], a[188:191], a[124:127], v[104:119]
    ds_read_b128 a[184:187], v11 offset:35840
    s_waitcnt lgkmcnt(3)
    v_mfma_f32_32x32x16_bf16 v[104:119], a[160:163], a[128:131], v[104:119]
    ds_read_b128 a[188:191], v11 offset:39936
    v_mfma_f32_32x32x16_bf16 v[104:119], a[164:167], a[132:135], v[104:119]
    v_mfma_f32_32x32x16_bf16 v[104:119], a[168:171], a[136:139], v[104:119]
    v_mfma_f32_32x32x16_bf16 v[104:119], a[172:175], a[140:143], v[104:119]
    s_waitcnt vmcnt(11)
    s_waitcnt lgkmcnt(0)
    s_barrier
    v_add_u32 v11, 0, v9
    v_add_u32 v12, 0, v10
    ds_read_b64_tr_b16 a[160:161], v11 offset:0
    ds_read_b64_tr_b16 a[162:163], v11 offset:512
    ds_read_b64_tr_b16 a[164:165], v12 offset:0
    ds_read_b64_tr_b16 a[166:167], v12 offset:512
    s_lshr_b32 s66, s3, 1
    s_add_u32 s66, s66, s50
    s_add_u32 s66, s66, 0
    s_and_b32 s66, s66, 3
    s_lshl_b32 s66, s66, 1
    s_and_b32 s67, s3, 1
    s_add_u32 s66, s66, s67
    s_mul_i32 s66, s66, 245760
    s_mul_i32 s67, s3, 5120
    s_add_u32 m0, s67, 81920
    s_nop 0
    buffer_load_dwordx4 v6, s[12:15], s66 offen lds
    v_mfma_f32_32x32x16_bf16 v[104:119], a[176:179], a[144:147], v[104:119]
    ds_read_b64_tr_b16 a[168:169], v11 offset:20480
    ds_read_b64_tr_b16 a[170:171], v11 offset:20992
    ds_read_b64_tr_b16 a[172:173], v12 offset:20480
    ds_read_b64_tr_b16 a[174:175], v12 offset:20992
    v_max3_f32 v44, v56, v57, v58
    v_min3_f32 v45, v56, v57, v58
    v_mfma_f32_32x32x16_bf16 v[104:119], a[180:183], a[148:151], v[104:119]
    ds_read_b64_tr_b16 a[176:177], v11 offset:2048
    ds_read_b64_tr_b16 a[178:179], v11 offset:2560
    v_max3_f32 v44, v44, v59, v60
    v_min3_f32 v45, v45, v59, v60
    v_max3_f32 v44, v44, v61, v62
    v_min3_f32 v45, v45, v61, v62
    v_mfma_f32_32x32x16_bf16 v[104:119], a[184:187], a[152:155], v[104:119]
    ds_read_b64_tr_b16 a[180:181], v12 offset:2048
    ds_read_b64_tr_b16 a[182:183], v12 offset:2560
    s_add_u32 m0, m0, 20480
    s_nop 0
    buffer_load_dwordx4 v6, s[16:19], s66 offen lds
    v_max3_f32 v44, v44, v63, v64
    v_min3_f32 v45, v45, v63, v64
    v_mfma_f32_32x32x16_bf16 v[104:119], a[188:191], a[156:159], v[104:119]
    ds_read_b64_tr_b16 a[184:185], v11 offset:22528
    ds_read_b64_tr_b16 a[186:187], v11 offset:23040
    v_max3_f32 v44, v44, v65, v66
    v_min3_f32 v45, v45, v65, v66
    v_max3_f32 v44, v44, v67, v68
    v_min3_f32 v45, v45, v67, v68
    s_waitcnt lgkmcnt(6)
    v_mfma_f32_32x32x16_bf16 v[120:135], a[160:163], a[80:83], v[120:135]
    ds_read_b64_tr_b16 a[188:189], v12 offset:22528
    ds_read_b64_tr_b16 a[190:191], v12 offset:23040
    v_max3_f32 v44, v44, v69, v70
    v_min3_f32 v45, v45, v69, v70
    v_max3_f32 v44, v44, v71, v72
    v_min3_f32 v45, v45, v71, v72
    v_max3_f32 v44, v44, v73, v74
    v_mfma_f32_32x32x16_bf16 v[136:151], a[164:167], a[80:83], v[136:151]
    ds_read_b64_tr_b16 a[160:161], v11 offset:4096
    ds_read_b64_tr_b16 a[162:163], v11 offset:4608
    s_add_u32 m0, m0, 4294947840
    s_add_u32 s66, s66, 49152
    buffer_load_dwordx4 v6, s[12:15], s66 offen lds
    v_min3_f32 v45, v45, v73, v74
    v_max_f32 v44, v44, v75
    v_mfma_f32_32x32x16_bf16 v[152:167], a[168:171], a[80:83], v[152:167]
    ds_read_b64_tr_b16 a[164:165], v12 offset:4096
    ds_read_b64_tr_b16 a[166:167], v12 offset:4608
    v_min_f32 v45, v45, v75
    v_mul_f32 v44, 1069066811, v44
    v_mul_f32 v45, 1069066811, v45
    s_mov_b32 s72, 1069066811
    v_fma_f32 v24, -v56, s72, v45
    v_mfma_f32_32x32x16_bf16 v[168:183], a[172:175], a[80:83], v[168:183]
    ds_read_b64_tr_b16 a[168:169], v11 offset:24576
    ds_read_b64_tr_b16 a[170:171], v11 offset:25088
    v_fma_f32 v56, v56, s72, -v44
    v_fma_f32 v25, -v57, s72, v45
    v_fma_f32 v57, v57, s72, -v44
    v_fma_f32 v26, -v58, s72, v45
    v_fma_f32 v58, v58, s72, -v44
    s_waitcnt lgkmcnt(6)
    v_mfma_f32_32x32x16_bf16 v[120:135], a[176:179], a[84:87], v[120:135]
    ds_read_b64_tr_b16 a[172:173], v12 offset:24576
    ds_read_b64_tr_b16 a[174:175], v12 offset:25088
    s_add_u32 m0, m0, 20480
    s_nop 0
    buffer_load_dwordx4 v6, s[16:19], s66 offen lds
    v_cvt_pk_bf16_f32 v202, v88, v89
    v_cvt_pk_bf16_f32 v203, v90, v91
    v_cvt_pk_bf16_f32 v204, v92, v93
    v_mfma_f32_32x32x16_bf16 v[136:151], a[180:183], a[84:87], v[136:151]
    ds_read_b64_tr_b16 a[176:177], v11 offset:6144
    ds_read_b64_tr_b16 a[178:179], v11 offset:6656
    v_cvt_pk_bf16_f32 v205, v94, v95
    v_mov_b32 v116, 0x3f80
    v_mov_b32 v117, 0
    ds_write_b64 v19, v[196:197] offset:0
    v_mfma_f32_32x32x16_bf16 v[152:167], a[184:187], a[84:87], v[152:167]
    ds_read_b64_tr_b16 a[180:181], v12 offset:6144
    ds_read_b64_tr_b16 a[182:183], v12 offset:6656
    v_mfma_f32_32x32x16_bf16 v[168:183], a[188:191], a[84:87], v[168:183]
    ds_read_b64_tr_b16 a[184:185], v11 offset:26624
    ds_read_b64_tr_b16 a[186:187], v11 offset:27136
    s_add_u32 m0, m0, 4294947840
    s_add_u32 s66, s66, 49152
    buffer_load_dwordx4 v6, s[12:15], s66 offen lds
    ds_write_b64 v19, v[198:199] offset:8
    s_waitcnt lgkmcnt(8)
    v_mfma_f32_32x32x16_bf16 v[120:135], a[160:163], a[88:91], v[120:135]
    ds_read_b64_tr_b16 a[188:189], v12 offset:26624
    ds_read_b64_tr_b16 a[190:191], v12 offset:27136
    v_mfma_f32_32x32x16_bf16 v[136:151], a[164:167], a[88:91], v[136:151]
    ds_read_b64_tr_b16 a[160:161], v11 offset:8192
    ds_read_b64_tr_b16 a[162:163], v11 offset:8704
    ds_write_b64 v19, v[200:201] offset:16
    v_mfma_f32_32x32x16_bf16 v[152:167], a[168:171], a[88:91], v[152:167]
    ds_read_b64_tr_b16 a[164:165], v12 offset:8192
    ds_read_b64_tr_b16 a[166:167], v12 offset:8704
    s_add_u32 m0, m0, 20480
    s_nop 0
    buffer_load_dwordx4 v6, s[16:19], s66 offen lds
    ds_write_b64 v19, v[202:203] offset:24
    v_mfma_f32_32x32x16_bf16 v[168:183], a[172:175], a[88:91], v[168:183]
    ds_read_b64_tr_b16 a[168:169], v11 offset:28672
    ds_read_b64_tr_b16 a[170:171], v11 offset:29184
    s_waitcnt lgkmcnt(8)
    v_mfma_f32_32x32x16_bf16 v[120:135], a[176:179], a[92:95], v[120:135]
    ds_read_b64_tr_b16 a[172:173], v12 offset:28672
    ds_read_b64_tr_b16 a[174:175], v12 offset:29184
    ds_write_b64 v19, v[204:205] offset:32
    v_mfma_f32_32x32x16_bf16 v[136:151], a[180:183], a[92:95], v[136:151]
    ds_read_b64_tr_b16 a[176:177], v11 offset:10240
    ds_read_b64_tr_b16 a[178:179], v11 offset:10752
    s_add_u32 m0, m0, 4294947840
    s_add_u32 s66, s66, 49152
    buffer_load_dwordx4 v6, s[12:15], s66 offen lds
    ds_write_b64 v19, v[116:117] offset:40
    v_fma_f32 v27, -v59, s72, v45
    v_mfma_f32_32x32x16_bf16 v[152:167], a[184:187], a[92:95], v[152:167]
    ds_read_b64_tr_b16 a[180:181], v12 offset:10240
    ds_read_b64_tr_b16 a[182:183], v12 offset:10752
    v_fma_f32 v59, v59, s72, -v44
    v_fma_f32 v28, -v60, s72, v45
    v_fma_f32 v60, v60, s72, -v44
    v_fma_f32 v29, -v61, s72, v45
    v_fma_f32 v61, v61, s72, -v44
    v_mfma_f32_32x32x16_bf16 v[168:183], a[188:191], a[92:95], v[168:183]
    ds_read_b64_tr_b16 a[184:185], v11 offset:30720
    ds_read_b64_tr_b16 a[186:187], v11 offset:31232
    v_fma_f32 v30, -v62, s72, v45
    v_fma_f32 v62, v62, s72, -v44
    v_fma_f32 v31, -v63, s72, v45
    v_fma_f32 v63, v63, s72, -v44
    v_fma_f32 v32, -v64, s72, v45
    s_waitcnt lgkmcnt(8)
    v_mfma_f32_32x32x16_bf16 v[120:135], a[160:163], a[96:99], v[120:135]
    ds_read_b64_tr_b16 a[188:189], v12 offset:30720
    ds_read_b64_tr_b16 a[190:191], v12 offset:31232
    s_add_u32 m0, m0, 20480
    s_nop 0
    buffer_load_dwordx4 v6, s[16:19], s66 offen lds
    v_fma_f32 v64, v64, s72, -v44
    v_fma_f32 v33, -v65, s72, v45
    v_fma_f32 v65, v65, s72, -v44
    v_mfma_f32_32x32x16_bf16 v[136:151], a[164:167], a[96:99], v[136:151]
    ds_read_b64_tr_b16 a[160:161], v11 offset:12288
    ds_read_b64_tr_b16 a[162:163], v11 offset:12800
    v_fma_f32 v34, -v66, s72, v45
    v_fma_f32 v66, v66, s72, -v44
    v_fma_f32 v35, -v67, s72, v45
    v_fma_f32 v67, v67, s72, -v44
    v_fma_f32 v36, -v68, s72, v45
    v_mfma_f32_32x32x16_bf16 v[152:167], a[168:171], a[96:99], v[152:167]
    ds_read_b64_tr_b16 a[164:165], v12 offset:12288
    ds_read_b64_tr_b16 a[166:167], v12 offset:12800
    v_fma_f32 v68, v68, s72, -v44
    v_fma_f32 v37, -v69, s72, v45
    v_fma_f32 v69, v69, s72, -v44
    v_fma_f32 v38, -v70, s72, v45
    v_fma_f32 v70, v70, s72, -v44
    v_mfma_f32_32x32x16_bf16 v[168:183], a[172:175], a[96:99], v[168:183]
    ds_read_b64_tr_b16 a[168:169], v11 offset:32768
    ds_read_b64_tr_b16 a[170:171], v11 offset:33280
    s_add_u32 m0, m0, 4294947840
    s_add_u32 s66, s66, 49152
    buffer_load_dwordx4 v6, s[12:15], s66 offen lds
    v_fma_f32 v39, -v71, s72, v45
    v_fma_f32 v71, v71, s72, -v44
    s_waitcnt lgkmcnt(6)
    v_mfma_f32_32x32x16_bf16 v[120:135], a[176:179], a[100:103], v[120:135]
    ds_read_b64_tr_b16 a[172:173], v12 offset:32768
    ds_read_b64_tr_b16 a[174:175], v12 offset:33280
    v_fma_f32 v40, -v72, s72, v45
    v_fma_f32 v72, v72, s72, -v44
    v_fma_f32 v41, -v73, s72, v45
    v_fma_f32 v73, v73, s72, -v44
    v_fma_f32 v42, -v74, s72, v45
    v_mfma_f32_32x32x16_bf16 v[136:151], a[180:183], a[100:103], v[136:151]
    ds_read_b64_tr_b16 a[176:177], v11 offset:14336
    ds_read_b64_tr_b16 a[178:179], v11 offset:14848
    v_fma_f32 v74, v74, s72, -v44
    v_fma_f32 v43, -v75, s72, v45
    v_fma_f32 v75, v75, s72, -v44
    v_exp_f32 v24, v24
    v_mfma_f32_32x32x16_bf16 v[152:167], a[184:187], a[100:103], v[152:167]
    ds_read_b64_tr_b16 a[180:181], v12 offset:14336
    ds_read_b64_tr_b16 a[182:183], v12 offset:14848
    s_add_u32 m0, m0, 20480
    s_nop 0
    buffer_load_dwordx4 v6, s[16:19], s66 offen lds
    v_exp_f32 v56, v56
    v_exp_f32 v25, v25
    v_mfma_f32_32x32x16_bf16 v[168:183], a[188:191], a[100:103], v[168:183]
    ds_read_b64_tr_b16 a[184:185], v11 offset:34816
    ds_read_b64_tr_b16 a[186:187], v11 offset:35328
    v_exp_f32 v57, v57
    v_exp_f32 v26, v26
    v_exp_f32 v58, v58
    s_waitcnt lgkmcnt(6)
    v_mfma_f32_32x32x16_bf16 v[120:135], a[160:163], a[104:107], v[120:135]
    ds_read_b64_tr_b16 a[188:189], v12 offset:34816
    ds_read_b64_tr_b16 a[190:191], v12 offset:35328
    v_exp_f32 v27, v27
    v_exp_f32 v59, v59
    v_exp_f32 v28, v28
    v_mfma_f32_32x32x16_bf16 v[136:151], a[164:167], a[104:107], v[136:151]
    ds_read_b64_tr_b16 a[160:161], v11 offset:16384
    ds_read_b64_tr_b16 a[162:163], v11 offset:16896
    v_exp_f32 v60, v60
    v_exp_f32 v29, v29
    v_exp_f32 v61, v61
    v_mfma_f32_32x32x16_bf16 v[152:167], a[168:171], a[104:107], v[152:167]
    ds_read_b64_tr_b16 a[164:165], v12 offset:16384
    ds_read_b64_tr_b16 a[166:167], v12 offset:16896
    v_exp_f32 v30, v30
    v_exp_f32 v62, v62
    v_exp_f32 v31, v31
    v_mfma_f32_32x32x16_bf16 v[168:183], a[172:175], a[104:107], v[168:183]
    ds_read_b64_tr_b16 a[168:169], v11 offset:36864
    ds_read_b64_tr_b16 a[170:171], v11 offset:37376
    v_exp_f32 v63, v63
    v_exp_f32 v32, v32
    v_exp_f32 v64, v64
    s_waitcnt lgkmcnt(6)
    v_mfma_f32_32x32x16_bf16 v[120:135], a[176:179], a[108:111], v[120:135]
    ds_read_b64_tr_b16 a[172:173], v12 offset:36864
    ds_read_b64_tr_b16 a[174:175], v12 offset:37376
    v_exp_f32 v33, v33
    v_exp_f32 v65, v65
    v_exp_f32 v34, v34
    v_mfma_f32_32x32x16_bf16 v[136:151], a[180:183], a[108:111], v[136:151]
    ds_read_b64_tr_b16 a[176:177], v11 offset:18432
    ds_read_b64_tr_b16 a[178:179], v11 offset:18944
    v_exp_f32 v66, v66
    v_exp_f32 v35, v35
    v_exp_f32 v67, v67
    v_mfma_f32_32x32x16_bf16 v[152:167], a[184:187], a[108:111], v[152:167]
    ds_read_b64_tr_b16 a[180:181], v12 offset:18432
    ds_read_b64_tr_b16 a[182:183], v12 offset:18944
    buffer_load_dwordx2 v[16:17], v14, s[28:31], s65 offen sc1
    v_exp_f32 v36, v36
    v_exp_f32 v68, v68
    v_mfma_f32_32x32x16_bf16 v[168:183], a[188:191], a[108:111], v[168:183]
    ds_read_b64_tr_b16 a[184:185], v11 offset:38912
    ds_read_b64_tr_b16 a[186:187], v11 offset:39424
    v_exp_f32 v37, v37
    v_exp_f32 v69, v69
    v_exp_f32 v38, v38
    s_waitcnt lgkmcnt(6)
    v_mfma_f32_32x32x16_bf16 v[120:135], a[160:163], a[112:115], v[120:135]
    ds_read_b64_tr_b16 a[188:189], v12 offset:38912
    ds_read_b64_tr_b16 a[190:191], v12 offset:39424
    v_exp_f32 v70, v70
    v_exp_f32 v39, v39
    v_exp_f32 v71, v71
    v_mfma_f32_32x32x16_bf16 v[136:151], a[164:167], a[112:115], v[136:151]
    v_exp_f32 v40, v40
    v_exp_f32 v72, v72
    v_exp_f32 v41, v41
    v_exp_f32 v73, v73
    v_mfma_f32_32x32x16_bf16 v[152:167], a[168:171], a[112:115], v[152:167]
    v_exp_f32 v42, v42
    v_exp_f32 v74, v74
    v_exp_f32 v43, v43
    v_exp_f32 v75, v75
    v_mfma_f32_32x32x16_bf16 v[168:183], a[172:175], a[112:115], v[168:183]
    s_waitcnt vmcnt(11)
    s_waitcnt lgkmcnt(0)
    s_barrier
    v_add_u32 v11, 40960, v9
    v_add_u32 v12, 40960, v10
    ds_read_b64_tr_b16 a[160:161], v11 offset:0
    ds_read_b64_tr_b16 a[162:163], v11 offset:512
    ds_read_b64_tr_b16 a[164:165], v12 offset:0
    ds_read_b64_tr_b16 a[166:167], v12 offset:512
    s_lshr_b32 s66, s3, 1
    s_add_u32 s66, s66, s50
    s_add_u32 s66, s66, 2
    s_and_b32 s66, s66, 3
    s_lshl_b32 s66, s66, 1
    s_and_b32 s67, s3, 1
    s_add_u32 s66, s66, s67
    s_mul_i32 s66, s66, 245760
    s_mul_i32 s67, s3, 5120
    s_add_u32 m0, s67, 0
    s_nop 0
    buffer_load_dwordx4 v6, s[12:15], s66 offen lds
    v_mfma_f32_32x32x16_bf16 v[120:135], a[176:179], a[116:119], v[120:135]
    ds_read_b64_tr_b16 a[168:169], v11 offset:20480
    ds_read_b64_tr_b16 a[170:171], v11 offset:20992
    ds_read_b64_tr_b16 a[172:173], v12 offset:20480
    ds_read_b64_tr_b16 a[174:175], v12 offset:20992
    v_add_f32 v46, v56, v57
    v_add_f32 v47, v24, v25
    v_add_f32 v46, v46, v58
    v_mfma_f32_32x32x16_bf16 v[136:151], a[180:183], a[116:119], v[136:151]
    ds_read_b64_tr_b16 a[176:177], v11 offset:2048
    ds_read_b64_tr_b16 a[178:179], v11 offset:2560
    v_add_f32 v47, v47, v26
    v_add_f32 v46, v46, v59
    v_add_f32 v47, v47, v27
    v_add_f32 v46, v46, v60
    v_add_f32 v47, v47, v28
    v_mfma_f32_32x32x16_bf16 v[152:167], a[184:187], a[116:119], v[152:167]
    ds_read_b64_tr_b16 a[180:181], v12 offset:2048
    ds_read_b64_tr_b16 a[182:183], v12 offset:2560
    s_add_u32 m0, m0, 20480
    s_nop 0
    buffer_load_dwordx4 v6, s[16:19], s66 offen lds
    v_add_f32 v46, v46, v61
    v_add_f32 v47, v47, v29
    v_add_f32 v46, v46, v62
    v_mfma_f32_32x32x16_bf16 v[168:183], a[188:191], a[116:119], v[168:183]
    ds_read_b64_tr_b16 a[184:185], v11 offset:22528
    ds_read_b64_tr_b16 a[186:187], v11 offset:23040
    v_add_f32 v47, v47, v30
    v_add_f32 v46, v46, v63
    v_add_f32 v47, v47, v31
    v_add_f32 v46, v46, v64
    v_add_f32 v47, v47, v32
    s_waitcnt lgkmcnt(6)
    v_mfma_f32_32x32x16_bf16 v[120:135], a[160:163], a[120:123], v[120:135]
    ds_read_b64_tr_b16 a[188:189], v12 offset:22528
    ds_read_b64_tr_b16 a[190:191], v12 offset:23040
    v_add_f32 v46, v46, v65
    v_add_f32 v47, v47, v33
    v_add_f32 v46, v46, v66
    v_add_f32 v47, v47, v34
    v_add_f32 v46, v46, v67
    v_mfma_f32_32x32x16_bf16 v[136:151], a[164:167], a[120:123], v[136:151]
    ds_read_b64_tr_b16 a[160:161], v11 offset:4096
    ds_read_b64_tr_b16 a[162:163], v11 offset:4608
    s_add_u32 m0, m0, 4294947840
    s_add_u32 s66, s66, 49152
    buffer_load_dwordx4 v6, s[12:15], s66 offen lds
    v_add_f32 v47, v47, v35
    v_add_f32 v46, v46, v68
    v_mfma_f32_32x32x16_bf16 v[152:167], a[168:171], a[120:123], v[152:167]
    ds_read_b64_tr_b16 a[164:165], v12 offset:4096
    ds_read_b64_tr_b16 a[166:167], v12 offset:4608
    v_add_f32 v47, v47, v36
    v_add_f32 v46, v46, v69
    v_add_f32 v47, v47, v37
    v_add_f32 v46, v46, v70
    v_add_f32 v47, v47, v38
    v_mfma_f32_32x32x16_bf16 v[168:183], a[172:175], a[120:123], v[168:183]
    ds_read_b64_tr_b16 a[168:169], v11 offset:24576
    ds_read_b64_tr_b16 a[170:171], v11 offset:25088
    v_add_f32 v46, v46, v71
    v_add_f32 v47, v47, v39
    v_add_f32 v46, v46, v72
    v_add_f32 v47, v47, v40
    v_add_f32 v46, v46, v73
    s_waitcnt lgkmcnt(6)
    v_mfma_f32_32x32x16_bf16 v[120:135], a[176:179], a[124:127], v[120:135]
    ds_read_b64_tr_b16 a[172:173], v12 offset:24576
    ds_read_b64_tr_b16 a[174:175], v12 offset:25088
    s_add_u32 m0, m0, 20480
    s_nop 0
    buffer_load_dwordx4 v6, s[16:19], s66 offen lds
    v_add_f32 v47, v47, v41
    v_add_f32 v46, v46, v74
    v_add_f32 v47, v47, v42
    v_mfma_f32_32x32x16_bf16 v[136:151], a[180:183], a[124:127], v[136:151]
    ds_read_b64_tr_b16 a[176:177], v11 offset:6144
    ds_read_b64_tr_b16 a[178:179], v11 offset:6656
    v_add_f32 v46, v46, v75
    v_add_f32 v47, v47, v43
    v_rcp_f32 v46, v46
    v_rcp_f32 v47, v47
    v_mfma_f32_32x32x16_bf16 v[152:167], a[184:187], a[124:127], v[152:167]
    ds_read_b64_tr_b16 a[180:181], v12 offset:6144
    ds_read_b64_tr_b16 a[182:183], v12 offset:6656
    v_mul_f32 v56, v56, v46
    v_mul_f32 v57, v57, v46
    v_cvt_pk_bf16_f32 v234, v56, v57
    v_mul_f32 v58, v58, v46
    v_mul_f32 v59, v59, v46
    v_mfma_f32_32x32x16_bf16 v[168:183], a[188:191], a[124:127], v[168:183]
    ds_read_b64_tr_b16 a[184:185], v11 offset:26624
    ds_read_b64_tr_b16 a[186:187], v11 offset:27136
    s_add_u32 m0, m0, 4294947840
    s_add_u32 s66, s66, 49152
    buffer_load_dwordx4 v6, s[12:15], s66 offen lds
    v_cvt_pk_bf16_f32 v235, v58, v59
    v_mul_f32 v60, v60, v46
    s_waitcnt lgkmcnt(6)
    v_mfma_f32_32x32x16_bf16 v[120:135], a[160:163], a[128:131], v[120:135]
    ds_read_b64_tr_b16 a[188:189], v12 offset:26624
    ds_read_b64_tr_b16 a[190:191], v12 offset:27136
    v_mul_f32 v61, v61, v46
    v_cvt_pk_bf16_f32 v236, v60, v61
    v_mul_f32 v62, v62, v46
    v_mul_f32 v63, v63, v46
    v_cvt_pk_bf16_f32 v237, v62, v63
    v_mfma_f32_32x32x16_bf16 v[136:151], a[164:167], a[128:131], v[136:151]
    ds_read_b64_tr_b16 a[160:161], v11 offset:8192
    ds_read_b64_tr_b16 a[162:163], v11 offset:8704
    ds_write_b128 v18, v[234:237] offset:0
    v_mul_f32 v64, v64, v46
    v_mul_f32 v65, v65, v46
    v_cvt_pk_bf16_f32 v238, v64, v65
    v_mul_f32 v66, v66, v46
    v_mfma_f32_32x32x16_bf16 v[152:167], a[168:171], a[128:131], v[152:167]
    ds_read_b64_tr_b16 a[164:165], v12 offset:8192
    ds_read_b64_tr_b16 a[166:167], v12 offset:8704
    s_add_u32 m0, m0, 20480
    s_nop 0
    buffer_load_dwordx4 v6, s[16:19], s66 offen lds
    v_mul_f32 v67, v67, v46
    v_cvt_pk_bf16_f32 v239, v66, v67
    v_mul_f32 v68, v68, v46
    v_mfma_f32_32x32x16_bf16 v[168:183], a[172:175], a[128:131], v[168:183]
    ds_read_b64_tr_b16 a[168:169], v11 offset:28672
    ds_read_b64_tr_b16 a[170:171], v11 offset:29184
    v_mul_f32 v69, v69, v46
    v_cvt_pk_bf16_f32 v240, v68, v69
    v_mul_f32 v70, v70, v46
    v_mul_f32 v71, v71, v46
    v_cvt_pk_bf16_f32 v241, v70, v71
    s_waitcnt lgkmcnt(7)
    v_mfma_f32_32x32x16_bf16 v[120:135], a[176:179], a[132:135], v[120:135]
    ds_read_b64_tr_b16 a[172:173], v12 offset:28672
    ds_read_b64_tr_b16 a[174:175], v12 offset:29184
    ds_write_b128 v18, v[238:241] offset:16
    v_mul_f32 v72, v72, v46
    v_mul_f32 v73, v73, v46
    v_cvt_pk_bf16_f32 v242, v72, v73
    v_mul_f32 v74, v74, v46
    v_mfma_f32_32x32x16_bf16 v[136:151], a[180:183], a[132:135], v[136:151]
    ds_read_b64_tr_b16 a[176:177], v11 offset:10240
    ds_read_b64_tr_b16 a[178:179], v11 offset:10752
    s_add_u32 m0, m0, 4294947840
    s_add_u32 s66, s66, 49152
    buffer_load_dwordx4 v6, s[12:15], s66 offen lds
    v_mul_f32 v75, v75, v46
    v_cvt_pk_bf16_f32 v243, v74, v75
    v_mfma_f32_32x32x16_bf16 v[152:167], a[184:187], a[132:135], v[152:167]
    ds_read_b64_tr_b16 a[180:181], v12 offset:10240
    ds_read_b64_tr_b16 a[182:183], v12 offset:10752
    v_mul_f32 v24, v24, v47
    v_mul_f32 v25, v25, v47
    v_cvt_pk_bf16_f32 v244, v24, v25
    v_mul_f32 v26, v26, v47
    v_mul_f32 v27, v27, v47
    v_mfma_f32_32x32x16_bf16 v[168:183], a[188:191], a[132:135], v[168:183]
    ds_read_b64_tr_b16 a[184:185], v11 offset:30720
    ds_read_b64_tr_b16 a[186:187], v11 offset:31232
    v_cvt_pk_bf16_f32 v245, v26, v27
    ds_write_b128 v18, v[242:245] offset:32
    v_mul_f32 v28, v28, v47
    v_mul_f32 v29, v29, v47
    v_cvt_pk_bf16_f32 v246, v28, v29
    s_waitcnt lgkmcnt(8)
    v_mfma_f32_32x32x16_bf16 v[120:135], a[160:163], a[136:139], v[120:135]
    ds_read_b64_tr_b16 a[188:189], v12 offset:30720
    ds_read_b64_tr_b16 a[190:191], v12 offset:31232
    s_add_u32 m0, m0, 20480
    s_nop 0
    buffer_load_dwordx4 v6, s[16:19], s66 offen lds
    v_mul_f32 v30, v30, v47
    v_mul_f32 v31, v31, v47
    v_cvt_pk_bf16_f32 v247, v30, v31
    v_mfma_f32_32x32x16_bf16 v[136:151], a[164:167], a[136:139], v[136:151]
    ds_read_b64_tr_b16 a[160:161], v11 offset:12288
    ds_read_b64_tr_b16 a[162:163], v11 offset:12800
    v_mul_f32 v32, v32, v47
    v_mul_f32 v33, v33, v47
    v_cvt_pk_bf16_f32 v248, v32, v33
    v_mul_f32 v34, v34, v47
    v_mul_f32 v35, v35, v47
    v_mfma_f32_32x32x16_bf16 v[152:167], a[168:171], a[136:139], v[152:167]
    ds_read_b64_tr_b16 a[164:165], v12 offset:12288
    ds_read_b64_tr_b16 a[166:167], v12 offset:12800
    v_cvt_pk_bf16_f32 v249, v34, v35
    ds_write_b128 v18, v[246:249] offset:48
    v_mul_f32 v36, v36, v47
    v_mul_f32 v37, v37, v47
    v_cvt_pk_bf16_f32 v250, v36, v37
    v_mfma_f32_32x32x16_bf16 v[168:183], a[172:175], a[136:139], v[168:183]
    ds_read_b64_tr_b16 a[168:169], v11 offset:32768
    ds_read_b64_tr_b16 a[170:171], v11 offset:33280
    s_add_u32 m0, m0, 4294947840
    s_add_u32 s66, s66, 49152
    buffer_load_dwordx4 v6, s[12:15], s66 offen lds
    v_mul_f32 v38, v38, v47
    v_mul_f32 v39, v39, v47
    s_waitcnt lgkmcnt(7)
    v_mfma_f32_32x32x16_bf16 v[120:135], a[176:179], a[140:143], v[120:135]
    ds_read_b64_tr_b16 a[172:173], v12 offset:32768
    s_branch L_padskip2
.p2align 12
L_pad2:
    s_setpc_b64 s[62:63]
L_padskip2:
    ds_read_b64_tr_b16 a[174:175], v12 offset:33280
    v_cvt_pk_bf16_f32 v251, v38, v39
    v_mul_f32 v40, v40, v47
    v_mul_f32 v41, v41, v47
    v_cvt_pk_bf16_f32 v252, v40, v41
    v_mul_f32 v42, v42, v47
    v_mfma_f32_32x32x16_bf16 v[136:151], a[180:183], a[140:143], v[136:151]
    ds_read_b64_tr_b16 a[176:177], v11 offset:14336
    ds_read_b64_tr_b16 a[178:179], v11 offset:14848
    v_mul_f32 v43, v43, v47
    v_cvt_pk_bf16_f32 v253, v42, v43
    ds_write_b128 v18, v[250:253] offset:64
    v_mfma_f32_32x32x16_bf16 v[152:167], a[184:187], a[140:143], v[152:167]
    ds_read_b64_tr_b16 a[180:181], v12 offset:14336
    ds_read_b64_tr_b16 a[182:183], v12 offset:14848
    s_add_u32 m0, m0, 20480
    s_nop 0
    buffer_load_dwordx4 v6, s[16:19], s66 offen lds
    v_mfma_f32_32x32x16_bf16 v[168:183], a[188:191], a[140:143], v[168:183]
    ds_read_b64_tr_b16 a[184:185], v11 offset:34816
    ds_read_b64_tr_b16 a[186:187], v11 offset:35328
    s_waitcnt lgkmcnt(7)
    v_mfma_f32_32x32x16_bf16 v[120:135], a[160:163], a[144:147], v[120:135]
    ds_read_b64_tr_b16 a[188:189], v12 offset:34816
    ds_read_b64_tr_b16 a[190:191], v12 offset:35328
    v_mfma_f32_32x32x16_bf16 v[136:151], a[164:167], a[144:147], v[136:151]
    ds_read_b64_tr_b16 a[160:161], v11 offset:16384
    ds_read_b64_tr_b16 a[162:163], v11 offset:16896
    v_mfma_f32_32x32x16_bf16 v[152:167], a[168:171], a[144:147], v[152:167]
    ds_read_b64_tr_b16 a[164:165], v12 offset:16384
    ds_read_b64_tr_b16 a[166:167], v12 offset:16896
    v_mfma_f32_32x32x16_bf16 v[168:183], a[172:175], a[144:147], v[168:183]
    ds_read_b64_tr_b16 a[168:169], v11 offset:36864
    ds_read_b64_tr_b16 a[170:171], v11 offset:37376
    s_waitcnt lgkmcnt(6)
    v_mfma_f32_32x32x16_bf16 v[120:135], a[176:179], a[148:151], v[120:135]
    ds_read_b64_tr_b16 a[172:173], v12 offset:36864
    ds_read_b64_tr_b16 a[174:175], v12 offset:37376
    v_mfma_f32_32x32x16_bf16 v[136:151], a[180:183], a[148:151], v[136:151]
    ds_read_b64_tr_b16 a[176:177], v11 offset:18432
    ds_read_b64_tr_b16 a[178:179], v11 offset:18944
    v_mfma_f32_32x32x16_bf16 v[152:167], a[184:187], a[148:151], v[152:167]
    ds_read_b64_tr_b16 a[180:181], v12 offset:18432
    ds_read_b64_tr_b16 a[182:183], v12 offset:18944
    v_mfma_f32_32x32x16_bf16 v[168:183], a[188:191], a[148:151], v[168:183]
    ds_read_b64_tr_b16 a[184:185], v11 offset:38912
    ds_read_b64_tr_b16 a[186:187], v11 offset:39424
    s_waitcnt lgkmcnt(6)
    v_mfma_f32_32x32x16_bf16 v[120:135], a[160:163], a[152:155], v[120:135]
    ds_read_b64_tr_b16 a[188:189], v12 offset:38912
    ds_read_b64_tr_b16 a[190:191], v12 offset:39424
    v_mfma_f32_32x32x16_bf16 v[136:151], a[164:167], a[152:155], v[136:151]
    v_mfma_f32_32x32x16_bf16 v[152:167], a[168:171], a[152:155], v[152:167]
    v_mfma_f32_32x32x16_bf16 v[168:183], a[172:175], a[152:155], v[168:183]
    s_waitcnt vmcnt(11)
    s_waitcnt lgkmcnt(0)
    s_barrier
    v_add_u32 v11, 81920, v8
    s_waitcnt vmcnt(10)
    v_cmp_ne_u64 vcc, s[44:45], v[16:17]
    s_nop 0
    s_cbranch_vccnz L_slow_16
L_back_17:
    ds_read_b64_tr_b16 a[160:161], v11 offset:0
    ds_read_b64_tr_b16 a[162:163], v11 offset:256
    ds_read_b64_tr_b16 a[164:165], v11 offset:20480
    ds_read_b64_tr_b16 a[166:167], v11 offset:20736
    v_mfma_f32_32x32x16_bf16 v[120:135], a[176:179], a[156:159], v[120:135]
    ds_read_b64_tr_b16 a[168:169], v11 offset:1024
    ds_read_b64_tr_b16 a[170:171], v11 offset:1280
    ds_read_b64_tr_b16 a[172:173], v11 offset:21504
    ds_read_b64_tr_b16 a[174:175], v11 offset:21760
    v_cvt_pk_bf16_f32 v206, v96, v97
    v_cvt_pk_bf16_f32 v207, v98, v99
    v_mfma_f32_32x32x16_bf16 v[136:151], a[180:183], a[156:159], v[136:151]
    ds_read_b64_tr_b16 a[176:177], v11 offset:2048
    ds_read_b64_tr_b16 a[178:179], v11 offset:2304
    v_cvt_pk_bf16_f32 v208, v100, v101
    v_cvt_pk_bf16_f32 v209, v102, v103
    v_cvt_pk_bf16_f32 v210, v104, v105
    v_cvt_pk_bf16_f32 v211, v106, v107
    v_mfma_f32_32x32x16_bf16 v[152:167], a[184:187], a[156:159], v[152:167]
    ds_read_b64_tr_b16 a[180:181], v11 offset:22528
    ds_read_b64_tr_b16 a[182:183], v11 offset:22784
    v_cvt_pk_bf16_f32 v212, v108, v109
    v_cvt_pk_bf16_f32 v213, v110, v111
    v_cvt_pk_bf16_f32 v214, v112, v113
    v_cvt_pk_bf16_f32 v215, v114, v115
    v_mfma_f32_32x32x16_bf16 v[168:183], a[188:191], a[156:159], v[168:183]
    ds_read_b64_tr_b16 a[184:185], v11 offset:3072
    ds_read_b64_tr_b16 a[186:187], v11 offset:3328
    v_mov_b32 v216, 0
    v_mov_b32 v217, 0
    ds_read_b64_tr_b16 a[216:217], v20 offset:0
    ds_read_b64_tr_b16 a[220:221], v21 offset:0
    s_waitcnt lgkmcnt(8)
    v_mfma_f32_32x32x16_bf16 v[24:39], a[160:163], a[0:3], 0
    ds_read_b64_tr_b16 a[188:189], v11 offset:23552
    ds_read_b64_tr_b16 a[190:191], v11 offset:23808
    ds_read_b64_tr_b16 a[218:219], v20 offset:704
    ds_read_b64_tr_b16 a[222:223], v21 offset:416
    ds_read_b64_tr_b16 a[224:225], v20 offset:2816
    ds_read_b64_tr_b16 a[228:229], v21 offset:1664
    v_mfma_f32_32x32x16_bf16 v[40:55], a[164:167], a[0:3], 0
    ds_read_b64_tr_b16 a[160:161], v11 offset:4096
    ds_read_b64_tr_b16 a[162:163], v11 offset:4352
    ds_read_b64_tr_b16 a[226:227], v20 offset:3520
    ds_read_b64_tr_b16 a[230:231], v21 offset:2080
    ds_read_b64_tr_b16 a[232:233], v20 offset:5632
    ds_read_b64_tr_b16 a[236:237], v21 offset:3328
    v_mfma_f32_32x32x16_bf16 v[24:39], a[168:171], a[4:7], v[24:39]
    ds_read_b64_tr_b16 a[164:165], v11 offset:24576
    ds_read_b64_tr_b16 a[166:167], v11 offset:24832
    s_add_u32 s75, s51, 0
    s_and_b32 s75, s75, 3
    s_mul_i32 s75, s75, 15360
    s_add_u32 s75, s75, s81
    buffer_load_dwordx4 a[0:3], v2, s[28:31], s75 offen offset:0 sc1
    v_mfma_f32_32x32x16_bf16 v[40:55], a[172:175], a[4:7], v[40:55]
    ds_read_b64_tr_b16 a[168:169], v11 offset:5120
    ds_read_b64_tr_b16 a[170:171], v11 offset:5376
    ds_read_b64_tr_b16 a[234:235], v20 offset:6336
    ds_read_b64_tr_b16 a[238:239], v21 offset:3744
    ds_read_b64_tr_b16 a[240:241], v20 offset:8448
    ds_read_b64_tr_b16 a[244:245], v21 offset:4992
    s_waitcnt lgkmcnt(15)
    v_mfma_f32_32x32x16_bf16 v[24:39], a[176:179], a[8:11], v[24:39]
    ds_read_b64_tr_b16 a[172:173], v11 offset:25600
    ds_read_b64_tr_b16 a[174:175], v11 offset:25856
    buffer_load_dwordx4 a[4:7], v2, s[28:31], s75 offen offset:1024 sc1
    ds_read_b64_tr_b16 a[242:243], v20 offset:9152
    ds_read_b64_tr_b16 a[246:247], v21 offset:5408
    s_waitcnt lgkmcnt(15)
    v_mfma_f32_32x32x16_bf16 v[88:103], a[216:219], a[220:223], 0
    v_mfma_f32_32x32x16_bf16 v[40:55], a[180:183], a[8:11], v[40:55]
    ds_read_b64_tr_b16 a[176:177], v11 offset:6144
    ds_read_b64_tr_b16 a[178:179], v11 offset:6400
    ds_read_b64_tr_b16 a[216:217], v20 offset:11264
    ds_read_b64_tr_b16 a[220:221], v21 offset:6656
    ds_read_b64_tr_b16 a[218:219], v20 offset:11968
    ds_read_b64_tr_b16 a[222:223], v21 offset:7072
    v_mfma_f32_32x32x16_bf16 v[24:39], a[184:187], a[12:15], v[24:39]
    ds_read_b64_tr_b16 a[180:181], v11 offset:26624
    ds_read_b64_tr_b16 a[182:183], v11 offset:26880
    buffer_load_dwordx4 a[8:11], v2, s[28:31], s75 offen offset:2048 sc1
    s_waitcnt lgkmcnt(15)
    v_mfma_f32_32x32x16_bf16 v[88:103], a[224:227], a[228:231], v[88:103]
    ds_read_b64_tr_b16 a[224:225], v20 offset:14080
    v_mfma_f32_32x32x16_bf16 v[40:55], a[188:191], a[12:15], v[40:55]
    ds_read_b64_tr_b16 a[184:185], v11 offset:7168
    ds_read_b64_tr_b16 a[186:187], v11 offset:7424
    ds_read_b64_tr_b16 a[228:229], v21 offset:8320
    ds_read_b64_tr_b16 a[226:227], v20 offset:14784
    ds_read_b64_tr_b16 a[230:231], v21 offset:8736
    s_waitcnt lgkmcnt(15)
    v_mfma_f32_32x32x16_bf16 v[88:103], a[232:235], a[236:239], v[88:103]
    s_waitcnt lgkmcnt(15)
    v_mfma_f32_32x32x16_bf16 v[24:39], a[160:163], a[16:19], v[24:39]
    ds_read_b64_tr_b16 a[188:189], v11 offset:27648
    ds_read_b64_tr_b16 a[190:191], v11 offset:27904
    buffer_load_dwordx4 a[12:15], v2, s[28:31], s75 offen offset:3072 sc1
    ds_read_b64_tr_b16 a[232:233], v20 offset:16896
    ds_read_b64_tr_b16 a[236:237], v21 offset:9984
    ds_read_b64_tr_b16 a[234:235], v20 offset:17600
    v_mfma_f32_32x32x16_bf16 v[40:55], a[164:167], a[16:19], v[40:55]
    ds_read_b64_tr_b16 a[160:161], v11 offset:8192
    ds_read_b64_tr_b16 a[162:163], v11 offset:8448
    ds_read_b64_tr_b16 a[238:239], v21 offset:10400
    s_waitcnt lgkmcnt(15)
    v_mfma_f32_32x32x16_bf16 v[88:103], a[240:243], a[244:247], v[88:103]
    ds_read_b64_tr_b16 a[240:241], v20 offset:19712
    v_mfma_f32_32x32x16_bf16 v[24:39], a[168:171], a[20:23], v[24:39]
    ds_read_b64_tr_b16 a[164:165], v11 offset:28672
    ds_read_b64_tr_b16 a[166:167], v11 offset:28928
    buffer_load_dwordx4 a[16:19], v0, s[28:31], s75 offen offset:0 sc1
    ds_read_b64_tr_b16 a[244:245], v21 offset:11648
    ds_read_b64_tr_b16 a[242:243], v20 offset:20416
    ds_read_b64_tr_b16 a[246:247], v21 offset:12064
    v_mfma_f32_32x32x16_bf16 v[40:55], a[172:175], a[20:23], v[40:55]
    ds_read_b64_tr_b16 a[168:169], v11 offset:9216
    ds_read_b64_tr_b16 a[170:171], v11 offset:9472
    s_waitcnt lgkmcnt(15)
    v_mfma_f32_32x32x16_bf16 v[88:103], a[216:219], a[220:223], v[88:103]
    s_waitcnt lgkmcnt(15)
    v_mfma_f32_32x32x16_bf16 v[88:103], a[224:227], a[228:231], v[88:103]
    s_waitcnt lgkmcnt(14)
    v_mfma_f32_32x32x16_bf16 v[24:39], a[176:179], a[24:27], v[24:39]
    ds_read_b64_tr_b16 a[172:173], v11 offset:29696
    ds_read_b64_tr_b16 a[174:175], v11 offset:29952
    s_add_u32 s75, s51, 0
    s_and_b32 s75, s75, 3
    s_mul_i32 s75, s75, 15360
    s_add_u32 s75, s75, s81
    s_add_u32 s75, s75, 5120
    buffer_load_dwordx4 a[20:23], v2, s[28:31], s75 offen offset:0 sc1
    v_mfma_f32_32x32x16_bf16 v[40:55], a[180:183], a[24:27], v[40:55]
    ds_read_b64_tr_b16 a[176:177], v11 offset:10240
    ds_read_b64_tr_b16 a[178:179], v11 offset:10496
    s_waitcnt lgkmcnt(12)
    v_mfma_f32_32x32x16_bf16 v[88:103], a[232:235], a[236:239], v[88:103]
    s_waitcnt lgkmcnt(6)
    v_mfma_f32_32x32x16_bf16 v[88:103], a[240:243], a[244:247], v[88:103]
    v_mfma_f32_32x32x16_bf16 v[24:39], a[184:187], a[28:31], v[24:39]
    ds_read_b64_tr_b16 a[180:181], v11 offset:30720
    ds_read_b64_tr_b16 a[182:183], v11 offset:30976
    buffer_load_dwordx4 a[24:27], v2, s[28:31], s75 offen offset:1024 sc1
    v_and_b32 v112, 31, v1
    v_lshrrev_b32 v113, 5, v1
    v_mul_u32_u24 v114, 80, v112
    v_mfma_f32_32x32x16_bf16 v[40:55], a[188:191], a[28:31], v[40:55]
    ds_read_b64_tr_b16 a[184:185], v11 offset:11264
    ds_read_b64_tr_b16 a[186:187], v11 offset:11520
    v_lshl_add_u32 v114, v113, 3, v114
    s_lshr_b32 s72, s3, 1
    s_mul_i32 s72, s72, 1680
    s_and_b32 s73, s3, 1
    s_waitcnt lgkmcnt(6)
    v_mfma_f32_32x32x16_bf16 v[24:39], a[160:163], a[32:35], v[24:39]
    ds_read_b64_tr_b16 a[188:189], v11 offset:31744
    ds_read_b64_tr_b16 a[190:191], v11 offset:32000
    buffer_load_dwordx4 a[28:31], v2, s[28:31], s75 offen offset:2048 sc1
    s_lshl_b32 s73, s73, 6
    s_add_u32 s72, s72, s73
    s_add_u32 s72, s72, 158720
    v_mfma_f32_32x32x16_bf16 v[40:55], a[164:167], a[32:35], v[40:55]
    ds_read_b64_tr_b16 a[160:161], v11 offset:12288
    ds_read_b64_tr_b16 a[162:163], v11 offset:12544
    v_add_u32 v114, s72, v114
    v_mov_b32 v115, 162112
    v_cmp_gt_u32 vcc, 21, v112
    s_nop 1
    v_cndmask_b32 v114, v115, v114, vcc
    v_mfma_f32_32x32x16_bf16 v[24:39], a[168:171], a[36:39], v[24:39]
    ds_read_b64_tr_b16 a[164:165], v11 offset:32768
    ds_read_b64_tr_b16 a[166:167], v11 offset:33024
    buffer_load_dwordx4 a[32:35], v2, s[28:31], s75 offen offset:3072 sc1
    s_cmp_eq_u32 s73, 0
    s_cselect_b64 vcc, -1, 0
    v_cndmask_b32 v116, v115, v114, vcc
    v_mfma_f32_32x32x16_bf16 v[40:55], a[172:175], a[36:39], v[40:55]
    ds_read_b64_tr_b16 a[168:169], v11 offset:13312
    ds_read_b64_tr_b16 a[170:171], v11 offset:13568
    v_cvt_pk_bf16_f32 v104, v88, v89
    v_cvt_pk_bf16_f32 v105, v90, v91
    ds_write_b64 v114, v[104:105] offset:0
    v_cvt_pk_bf16_f32 v106, v92, v93
    s_waitcnt lgkmcnt(7)
    v_mfma_f32_32x32x16_bf16 v[24:39], a[176:179], a[40:43], v[24:39]
    ds_read_b64_tr_b16 a[172:173], v11 offset:33792
    ds_read_b64_tr_b16 a[174:175], v11 offset:34048
    buffer_load_dwordx4 a[36:39], v0, s[28:31], s75 offen offset:0 sc1
    v_cvt_pk_bf16_f32 v107, v94, v95
    ds_write_b64 v116, v[106:107] offset:16
    v_cvt_pk_bf16_f32 v108, v96, v97
    v_mfma_f32_32x32x16_bf16 v[40:55], a[180:183], a[40:43], v[40:55]
    ds_read_b64_tr_b16 a[176:177], v11 offset:14336
    ds_read_b64_tr_b16 a[178:179], v11 offset:14592
    v_cvt_pk_bf16_f32 v109, v98, v99
    ds_write_b64 v116, v[108:109] offset:32
    v_cvt_pk_bf16_f32 v110, v100, v101
    v_cvt_pk_bf16_f32 v111, v102, v103
    v_mfma_f32_32x32x16_bf16 v[24:39], a[184:187], a[44:47], v[24:39]
    ds_read_b64_tr_b16 a[180:181], v11 offset:34816
    ds_read_b64_tr_b16 a[182:183], v11 offset:35072
    s_add_u32 s75, s51, 0
    s_and_b32 s75, s75, 3
    s_mul_i32 s75, s75, 15360
    s_add_u32 s75, s75, s81
    s_add_u32 s75, s75, 10240
    buffer_load_dwordx4 a[40:43], v2, s[28:31], s75 offen offset:0 sc1
    v_mfma_f32_32x32x16_bf16 v[40:55], a[188:191], a[44:47], v[40:55]
    ds_read_b64_tr_b16 a[184:185], v11 offset:15360
    ds_read_b64_tr_b16 a[186:187], v11 offset:15616
    ds_write_b64 v116, v[110:111] offset:48
    v_max_f32 v120, 0, v120
    v_mul_f32 v120, v120, v152
    v_max_f32 v121, 0, v121
    s_waitcnt lgkmcnt(9)
    v_mfma_f32_32x32x16_bf16 v[24:39], a[160:163], a[48:51], v[24:39]
    ds_read_b64_tr_b16 a[188:189], v11 offset:35840
    ds_read_b64_tr_b16 a[190:191], v11 offset:36096
    buffer_load_dwordx4 a[44:47], v2, s[28:31], s75 offen offset:1024 sc1
    v_mul_f32 v121, v121, v153
    v_cvt_pk_bf16_f32 v218, v120, v121
    v_max_f32 v122, 0, v122
    v_mfma_f32_32x32x16_bf16 v[40:55], a[164:167], a[48:51], v[40:55]
    ds_read_b64_tr_b16 a[160:161], v11 offset:16384
    ds_read_b64_tr_b16 a[162:163], v11 offset:16640
    v_mul_f32 v122, v122, v154
    v_max_f32 v123, 0, v123
    v_mul_f32 v123, v123, v155
    v_cvt_pk_bf16_f32 v219, v122, v123
    v_mfma_f32_32x32x16_bf16 v[24:39], a[168:171], a[52:55], v[24:39]
    ds_read_b64_tr_b16 a[164:165], v11 offset:36864
    ds_read_b64_tr_b16 a[166:167], v11 offset:37120
    buffer_load_dwordx4 a[48:51], v2, s[28:31], s75 offen offset:2048 sc1
    v_max_f32 v124, 0, v124
    v_mul_f32 v124, v124, v156
    v_max_f32 v125, 0, v125
    v_mfma_f32_32x32x16_bf16 v[40:55], a[172:175], a[52:55], v[40:55]
    ds_read_b64_tr_b16 a[168:169], v11 offset:17408
    ds_read_b64_tr_b16 a[170:171], v11 offset:17664
    v_mul_f32 v125, v125, v157
    v_cvt_pk_bf16_f32 v220, v124, v125
    v_max_f32 v126, 0, v126
    v_mul_f32 v126, v126, v158
    s_waitcnt lgkmcnt(6)
    v_mfma_f32_32x32x16_bf16 v[24:39], a[176:179], a[56:59], v[24:39]
    ds_read_b64_tr_b16 a[172:173], v11 offset:37888
    ds_read_b64_tr_b16 a[174:175], v11 offset:38144
    buffer_load_dwordx4 a[52:55], v2, s[28:31], s75 offen offset:3072 sc1
    v_max_f32 v127, 0, v127
    v_mul_f32 v127, v127, v159
    v_cvt_pk_bf16_f32 v221, v126, v127
    v_mfma_f32_32x32x16_bf16 v[40:55], a[180:183], a[56:59], v[40:55]
    ds_read_b64_tr_b16 a[176:177], v11 offset:18432
    ds_read_b64_tr_b16 a[178:179], v11 offset:18688
    v_max_f32 v128, 0, v128
    v_mul_f32 v128, v128, v160
    v_max_f32 v129, 0, v129
    v_mul_f32 v129, v129, v161
    v_mfma_f32_32x32x16_bf16 v[24:39], a[184:187], a[60:63], v[24:39]
    ds_read_b64_tr_b16 a[180:181], v11 offset:38912
    ds_read_b64_tr_b16 a[182:183], v11 offset:39168
    buffer_load_dwordx4 a[56:59], v0, s[28:31], s75 offen offset:0 sc1
    v_cvt_pk_bf16_f32 v222, v128, v129
    v_max_f32 v130, 0, v130
    v_mul_f32 v130, v130, v162
    v_mfma_f32_32x32x16_bf16 v[40:55], a[188:191], a[60:63], v[40:55]
    ds_read_b64_tr_b16 a[184:185], v11 offset:19456
    ds_read_b64_tr_b16 a[186:187], v11 offset:19712
    v_max_f32 v131, 0, v131
    v_mul_f32 v131, v131, v163
    v_cvt_pk_bf16_f32 v223, v130, v131
    v_max_f32 v132, 0, v132
    s_waitcnt lgkmcnt(6)
    v_mfma_f32_32x32x16_bf16 v[24:39], a[160:163], a[64:67], v[24:39]
    ds_read_b64_tr_b16 a[188:189], v11 offset:39936
    ds_read_b64_tr_b16 a[190:191], v11 offset:40192
    s_add_u32 s75, s51, 1
    s_and_b32 s75, s75, 3
    s_mul_i32 s75, s75, 15360
    s_add_u32 s75, s75, s81
    buffer_load_dwordx4 a[60:63], v2, s[28:31], s75 offen offset:0 sc1
    v_mfma_f32_32x32x16_bf16 v[40:55], a[164:167], a[64:67], v[40:55]
    v_mul_f32 v132, v132, v164
    v_max_f32 v133, 0, v133
    v_mul_f32 v133, v133, v165
    v_cvt_pk_bf16_f32 v224, v132, v133
    v_max_f32 v134, 0, v134
    v_mul_f32 v134, v134, v166
    v_mfma_f32_32x32x16_bf16 v[24:39], a[168:171], a[68:71], v[24:39]
    buffer_load_dwordx4 a[64:67], v2, s[28:31], s75 offen offset:1024 sc1
    v_max_f32 v135, 0, v135
    v_mul_f32 v135, v135, v167
    v_cvt_pk_bf16_f32 v225, v134, v135
    buffer_store_dwordx4 v[218:221], v13, s[28:31], s71 offen offset:0 sc1
    buffer_store_dwordx4 v[222:225], v13, s[28:31], s71 offen offset:512 sc1
    v_mfma_f32_32x32x16_bf16 v[40:55], a[172:175], a[68:71], v[40:55]
    s_waitcnt vmcnt(19)
    s_waitcnt lgkmcnt(0)
    s_barrier
    v_add_u32 v11, 0, v8
    ds_read_b64_tr_b16 a[160:161], v11 offset:0
    ds_read_b64_tr_b16 a[162:163], v11 offset:256
    ds_read_b64_tr_b16 a[164:165], v11 offset:20480
    ds_read_b64_tr_b16 a[166:167], v11 offset:20736
    v_mfma_f32_32x32x16_bf16 v[24:39], a[176:179], a[72:75], v[24:39]
    ds_read_b64_tr_b16 a[168:169], v11 offset:1024
    ds_read_b64_tr_b16 a[170:171], v11 offset:1280
    ds_read_b64_tr_b16 a[172:173], v11 offset:21504
    ds_read_b64_tr_b16 a[174:175], v11 offset:21760
    buffer_load_dwordx4 a[68:71], v2, s[28:31], s75 offen offset:2048 sc1
    s_mul_i32 s72, s3, 53
    v_mfma_f32_32x32x16_bf16 v[40:55], a[180:183], a[72:75], v[40:55]
    ds_read_b64_tr_b16 a[176:177], v11 offset:2048
    ds_read_b64_tr_b16 a[178:179], v11 offset:2304
    v_add_u32 v112, s72, v1
    v_cmp_gt_u32 vcc, 210, v112
    v_lshlrev_b32 v112, 4, v112
    v_mov_b32 v113, 1073741824
    v_cndmask_b32 v112, v113, v112, vcc
    v_mfma_f32_32x32x16_bf16 v[24:39], a[184:187], a[76:79], v[24:39]
    ds_read_b64_tr_b16 a[180:181], v11 offset:22528
    ds_read_b64_tr_b16 a[182:183], v11 offset:22784
    buffer_load_dwordx4 a[72:75], v2, s[28:31], s75 offen offset:3072 sc1
    v_cmp_gt_u32 vcc, 53, v1
    s_nop 1
    v_cndmask_b32 v112, v113, v112, vcc
    v_min_u32 v114, 3392, v112
    v_mfma_f32_32x32x16_bf16 v[40:55], a[188:191], a[76:79], v[40:55]
    ds_read_b64_tr_b16 a[184:185], v11 offset:3072
    ds_read_b64_tr_b16 a[186:187], v11 offset:3328
    v_add_u32 v114, 158720, v114
    ds_read_b128 v[88:91], v114
    s_lshl_b32 s72, s47, 4
    s_add_u32 s72, s72, s46
    s_waitcnt lgkmcnt(7)
    v_mfma_f32_32x32x16_bf16 v[24:39], a[160:163], a[80:83], v[24:39]
    ds_read_b64_tr_b16 a[188:189], v11 offset:23552
    ds_read_b64_tr_b16 a[190:191], v11 offset:23808
    buffer_load_dwordx4 a[76:79], v0, s[28:31], s75 offen offset:0 sc1
    s_mul_i32 s72, s72, 3456
    s_add_u32 s72, s72, 19922944
    s_waitcnt lgkmcnt(2)
    buffer_store_dwordx4 v[88:91], v112, s[28:31], s72 offen sc1
    v_mfma_f32_32x32x16_bf16 v[40:55], a[164:167], a[80:83], v[40:55]
    ds_read_b64_tr_b16 a[160:161], v11 offset:4096
    ds_read_b64_tr_b16 a[162:163], v11 offset:4352
    v_max_f32 v136, 0, v136
    v_mul_f32 v136, v136, v168
    v_max_f32 v137, 0, v137
    v_mul_f32 v137, v137, v169
    v_mfma_f32_32x32x16_bf16 v[24:39], a[168:171], a[84:87], v[24:39]
    ds_read_b64_tr_b16 a[164:165], v11 offset:24576
    ds_read_b64_tr_b16 a[166:167], v11 offset:24832
    s_add_u32 s75, s51, 1
    s_and_b32 s75, s75, 3
    s_mul_i32 s75, s75, 15360
    s_add_u32 s75, s75, s81
    s_add_u32 s75, s75, 5120
    buffer_load_dwordx4 a[80:83], v2, s[28:31], s75 offen offset:0 sc1
    v_mfma_f32_32x32x16_bf16 v[40:55], a[172:175], a[84:87], v[40:55]
    ds_read_b64_tr_b16 a[168:169], v11 offset:5120
    ds_read_b64_tr_b16 a[170:171], v11 offset:5376
    v_cvt_pk_bf16_f32 v226, v136, v137
    v_max_f32 v138, 0, v138
    v_mul_f32 v138, v138, v170
    v_max_f32 v139, 0, v139
    s_waitcnt lgkmcnt(6)
    v_mfma_f32_32x32x16_bf16 v[24:39], a[176:179], a[88:91], v[24:39]
    ds_read_b64_tr_b16 a[172:173], v11 offset:25600
    ds_read_b64_tr_b16 a[174:175], v11 offset:25856
    buffer_load_dwordx4 a[84:87], v2, s[28:31], s75 offen offset:1024 sc1
    v_mul_f32 v139, v139, v171
    v_cvt_pk_bf16_f32 v227, v138, v139
    v_max_f32 v140, 0, v140
    v_mfma_f32_32x32x16_bf16 v[40:55], a[180:183], a[88:91], v[40:55]
    ds_read_b64_tr_b16 a[176:177], v11 offset:6144
    ds_read_b64_tr_b16 a[178:179], v11 offset:6400
    v_mul_f32 v140, v140, v172
    v_max_f32 v141, 0, v141
    v_mul_f32 v141, v141, v173
    v_cvt_pk_bf16_f32 v228, v140, v141
    v_mfma_f32_32x32x16_bf16 v[24:39], a[184:187], a[92:95], v[24:39]
    ds_read_b64_tr_b16 a[180:181], v11 offset:26624
    ds_read_b64_tr_b16 a[182:183], v11 offset:26880
    buffer_load_dwordx4 a[88:91], v2, s[28:31], s75 offen offset:2048 sc1
    v_max_f32 v142, 0, v142
    v_mul_f32 v142, v142, v174
    v_max_f32 v143, 0, v143
    v_mfma_f32_32x32x16_bf16 v[40:55], a[188:191], a[92:95], v[40:55]
    ds_read_b64_tr_b16 a[184:185], v11 offset:7168
    ds_read_b64_tr_b16 a[186:187], v11 offset:7424
    v_mul_f32 v143, v143, v175
    v_cvt_pk_bf16_f32 v229, v142, v143
    v_max_f32 v144, 0, v144
    v_mul_f32 v144, v144, v176
    s_waitcnt lgkmcnt(6)
    v_mfma_f32_32x32x16_bf16 v[24:39], a[160:163], a[96:99], v[24:39]
    ds_read_b64_tr_b16 a[188:189], v11 offset:27648
    ds_read_b64_tr_b16 a[190:191], v11 offset:27904
    buffer_load_dwordx4 a[92:95], v2, s[28:31], s75 offen offset:3072 sc1
    v_max_f32 v145, 0, v145
    v_mul_f32 v145, v145, v177
    v_cvt_pk_bf16_f32 v230, v144, v145
    v_mfma_f32_32x32x16_bf16 v[40:55], a[164:167], a[96:99], v[40:55]
    ds_read_b64_tr_b16 a[160:161], v11 offset:8192
    ds_read_b64_tr_b16 a[162:163], v11 offset:8448
    v_max_f32 v146, 0, v146
    v_mul_f32 v146, v146, v178
    v_max_f32 v147, 0, v147
    v_mul_f32 v147, v147, v179
    v_mfma_f32_32x32x16_bf16 v[24:39], a[168:171], a[100:103], v[24:39]
    ds_read_b64_tr_b16 a[164:165], v11 offset:28672
    ds_read_b64_tr_b16 a[166:167], v11 offset:28928
    buffer_load_dwordx4 a[96:99], v0, s[28:31], s75 offen offset:0 sc1
    v_cvt_pk_bf16_f32 v231, v146, v147
    v_max_f32 v148, 0, v148
    v_mul_f32 v148, v148, v180
    v_mfma_f32_32x32x16_bf16 v[40:55], a[172:175], a[100:103], v[40:55]
    ds_read_b64_tr_b16 a[168:169], v11 offset:9216
    ds_read_b64_tr_b16 a[170:171], v11 offset:9472
    v_max_f32 v149, 0, v149
    v_mul_f32 v149, v149, v181
    v_cvt_pk_bf16_f32 v232, v148, v149
    v_max_f32 v150, 0, v150
    s_waitcnt lgkmcnt(6)
    v_mfma_f32_32x32x16_bf16 v[24:39], a[176:179], a[104:107], v[24:39]
    ds_read_b64_tr_b16 a[172:173], v11 offset:29696
    ds_read_b64_tr_b16 a[174:175], v11 offset:29952
    s_add_u32 s75, s51, 1
    s_and_b32 s75, s75, 3
    s_mul_i32 s75, s75, 15360
    s_add_u32 s75, s75, s81
    s_add_u32 s75, s75, 10240
    buffer_load_dwordx4 a[100:103], v2, s[28:31], s75 offen offset:0 sc1
    v_mfma_f32_32x32x16_bf16 v[40:55], a[180:183], a[104:107], v[40:55]
    ds_read_b64_tr_b16 a[176:177], v11 offset:10240
    ds_read_b64_tr_b16 a[178:179], v11 offset:10496
    v_mul_f32 v150, v150, v182
    v_max_f32 v151, 0, v151
    v_mul_f32 v151, v151, v183
    v_cvt_pk_bf16_f32 v233, v150, v151
    v_mfma_f32_32x32x16_bf16 v[24:39], a[184:187], a[108:111], v[24:39]
    ds_read_b64_tr_b16 a[180:181], v11 offset:30720
    ds_read_b64_tr_b16 a[182:183], v11 offset:30976
    buffer_load_dwordx4 a[104:107], v2, s[28:31], s75 offen offset:1024 sc1
    s_add_u32 s61, s71, 4096
    buffer_store_dwordx4 v[226:229], v13, s[28:31], s61 offen offset:0 sc1
    buffer_store_dwordx4 v[230:233], v13, s[28:31], s61 offen offset:512 sc1
    v_mfma_f32_32x32x16_bf16 v[40:55], a[188:191], a[108:111], v[40:55]
    ds_read_b64_tr_b16 a[184:185], v11 offset:11264
    ds_read_b64_tr_b16 a[186:187], v11 offset:11520
    s_waitcnt lgkmcnt(6)
    v_mfma_f32_32x32x16_bf16 v[24:39], a[160:163], a[112:115], v[24:39]
    ds_read_b64_tr_b16 a[188:189], v11 offset:31744
    ds_read_b64_tr_b16 a[190:191], v11 offset:32000
    buffer_load_dwordx4 a[108:111], v2, s[28:31], s75 offen offset:2048 sc1
    s_waitcnt vmcnt(10)
    s_lshl_b32 s63, s2, 7
    s_lshl_b32 s62, s3, 3
    s_add_u32 s63, s63, s62
    s_add_u32 s63, s63, 102400
    buffer_store_dwordx2 v[4:5], v3, s[28:31], s63 offen sc1
    v_mfma_f32_32x32x16_bf16 v[40:55], a[164:167], a[112:115], v[40:55]
    ds_read_b64_tr_b16 a[160:161], v11 offset:12288
    ds_read_b64_tr_b16 a[162:163], v11 offset:12544
    v_mfma_f32_32x32x16_bf16 v[24:39], a[168:171], a[116:119], v[24:39]
    ds_read_b64_tr_b16 a[164:165], v11 offset:32768
    ds_read_b64_tr_b16 a[166:167], v11 offset:33024
    buffer_load_dwordx4 a[112:115], v2, s[28:31], s75 offen offset:3072 sc1
    v_mfma_f32_32x32x16_bf16 v[40:55], a[172:175], a[116:119], v[40:55]
    ds_read_b64_tr_b16 a[168:169], v11 offset:13312
    ds_read_b64_tr_b16 a[170:171], v11 offset:13568
    s_waitcnt lgkmcnt(6)
    v_mfma_f32_32x32x16_bf16 v[24:39], a[176:179], a[120:123], v[24:39]
    ds_read_b64_tr_b16 a[172:173], v11 offset:33792
    ds_read_b64_tr_b16 a[174:175], v11 offset:34048
    buffer_load_dwordx4 a[116:119], v0, s[28:31], s75 offen offset:0 sc1
    v_mfma_f32_32x32x16_bf16 v[40:55], a[180:183], a[120:123], v[40:55]
    ds_read_b64_tr_b16 a[176:177], v11 offset:14336
    ds_read_b64_tr_b16 a[178:179], v11 offset:14592
    v_mfma_f32_32x32x16_bf16 v[24:39], a[184:187], a[124:127], v[24:39]
    ds_read_b64_tr_b16 a[180:181], v11 offset:34816
    ds_read_b64_tr_b16 a[182:183], v11 offset:35072
    s_add_u32 s75, s51, 2
    s_and_b32 s75, s75, 3
    s_mul_i32 s75, s75, 15360
    s_add_u32 s75, s75, s81
    buffer_load_dwordx4 a[120:123], v2, s[28:31], s75 offen offset:0 sc1
    v_mfma_f32_32x32x16_bf16 v[40:55], a[188:191], a[124:127], v[40:55]
    ds_read_b64_tr_b16 a[184:185], v11 offset:15360
    ds_read_b64_tr_b16 a[186:187], v11 offset:15616
    s_waitcnt lgkmcnt(6)
    v_mfma_f32_32x32x16_bf16 v[24:39], a[160:163], a[128:131], v[24:39]
    ds_read_b64_tr_b16 a[188:189], v11 offset:35840
    ds_read_b64_tr_b16 a[190:191], v11 offset:36096
    buffer_load_dwordx4 a[124:127], v2, s[28:31], s75 offen offset:1024 sc1
    v_mfma_f32_32x32x16_bf16 v[40:55], a[164:167], a[128:131], v[40:55]
    ds_read_b64_tr_b16 a[160:161], v11 offset:16384
    ds_read_b64_tr_b16 a[162:163], v11 offset:16640
    v_mfma_f32_32x32x16_bf16 v[24:39], a[168:171], a[132:135], v[24:39]
    ds_read_b64_tr_b16 a[164:165], v11 offset:36864
    ds_read_b64_tr_b16 a[166:167], v11 offset:37120
    v_mfma_f32_32x32x16_bf16 v[40:55], a[172:175], a[132:135], v[40:55]
    ds_read_b64_tr_b16 a[168:169], v11 offset:17408
    ds_read_b64_tr_b16 a[170:171], v11 offset:17664
    s_waitcnt lgkmcnt(6)
    v_mfma_f32_32x32x16_bf16 v[24:39], a[176:179], a[136:139], v[24:39]
    ds_read_b64_tr_b16 a[172:173], v11 offset:37888
    ds_read_b64_tr_b16 a[174:175], v11 offset:38144
    v_mfma_f32_32x32x16_bf16 v[40:55], a[180:183], a[136:139], v[40:55]
    ds_read_b64_tr_b16 a[176:177], v11 offset:18432
    ds_read_b64_tr_b16 a[178:179], v11 offset:18688
    v_mfma_f32_32x32x16_bf16 v[24:39], a[184:187], a[140:143], v[24:39]
    ds_read_b64_tr_b16 a[180:181], v11 offset:38912
    ds_read_b64_tr_b16 a[182:183], v11 offset:39168
    v_lshrrev_b32 v248, 2, v1
    v_and_b32 v249, 7, v248
    v_lshlrev_b32 v249, 5, v249
    v_lshrrev_b32 v248, 3, v248
    v_mfma_f32_32x32x16_bf16 v[40:55], a[188:191], a[140:143], v[40:55]
    ds_read_b64_tr_b16 a[184:185], v11 offset:19456
    ds_read_b64_tr_b16 a[186:187], v11 offset:19712
    v_lshl_add_u32 v249, v248, 2, v249
    v_lshlrev_b32 v249, 7, v249
    v_and_b32 v248, 3, v1
    v_lshl_add_u32 v14, v248, 3, v249
    s_waitcnt lgkmcnt(6)
    v_mfma_f32_32x32x16_bf16 v[24:39], a[160:163], a[144:147], v[24:39]
    ds_read_b64_tr_b16 a[188:189], v11 offset:39936
    ds_read_b64_tr_b16 a[190:191], v11 offset:40192
    s_and_b32 s52, s47, 3
    s_lshl_b32 s52, s52, 3
    s_lshr_b32 s53, s47, 2
    s_branch L_padskip3
.p2align 12
L_pad3:
    s_setpc_b64 s[62:63]
L_padskip3:
    s_add_u32 s53, s53, 0
    v_mfma_f32_32x32x16_bf16 v[40:55], a[164:167], a[144:147], v[40:55]
    s_and_b32 s53, s53, 3
    s_add_u32 s52, s52, s53
    s_lshl_b32 s52, s52, 7
    s_add_u32 s65, s52, 102400
    v_mfma_f32_32x32x16_bf16 v[24:39], a[168:171], a[148:151], v[24:39]
    v_mfma_f32_32x32x16_bf16 v[40:55], a[172:175], a[148:151], v[40:55]
    s_waitcnt lgkmcnt(0)
    v_mfma_f32_32x32x16_bf16 v[24:39], a[176:179], a[152:155], v[24:39]
    v_mfma_f32_32x32x16_bf16 v[40:55], a[180:183], a[152:155], v[40:55]
    v_mfma_f32_32x32x16_bf16 v[24:39], a[184:187], a[156:159], v[24:39]
    v_mfma_f32_32x32x16_bf16 v[40:55], a[188:191], a[156:159], v[40:55]
    s_waitcnt lgkmcnt(0)
    s_barrier
    s_nop 8
    v_max_f32 v24, 0, v24
    v_max_f32 v25, 0, v25
    v_pk_mul_f32 v[24:25], v[24:25], v[40:41]
    v_cvt_pk_bf16_f32 v218, v24, v25
    v_max_f32 v26, 0, v26
    v_max_f32 v27, 0, v27
    v_pk_mul_f32 v[26:27], v[26:27], v[42:43]
    v_cvt_pk_bf16_f32 v219, v26, v27
    v_max_f32 v28, 0, v28
    v_max_f32 v29, 0, v29
    v_pk_mul_f32 v[28:29], v[28:29], v[44:45]
    v_cvt_pk_bf16_f32 v220, v28, v29
    v_max_f32 v30, 0, v30
    v_max_f32 v31, 0, v31
    v_pk_mul_f32 v[30:31], v[30:31], v[46:47]
    v_cvt_pk_bf16_f32 v221, v30, v31
    v_max_f32 v32, 0, v32
    v_max_f32 v33, 0, v33
    v_pk_mul_f32 v[32:33], v[32:33], v[48:49]
    v_cvt_pk_bf16_f32 v222, v32, v33
    v_max_f32 v34, 0, v34
    v_max_f32 v35, 0, v35
    v_pk_mul_f32 v[34:35], v[34:35], v[50:51]
    v_cvt_pk_bf16_f32 v223, v34, v35
    v_max_f32 v36, 0, v36
    v_max_f32 v37, 0, v37
    v_pk_mul_f32 v[36:37], v[36:37], v[52:53]
    v_cvt_pk_bf16_f32 v224, v36, v37
    v_max_f32 v38, 0, v38
    v_max_f32 v39, 0, v39
    v_pk_mul_f32 v[38:39], v[38:39], v[54:55]
    v_cvt_pk_bf16_f32 v225, v38, v39
    buffer_store_dwordx4 v[218:221], v13, s[28:31], s70 offen offset:0 sc1
    buffer_store_dwordx4 v[222:225], v13, s[28:31], s70 offen offset:512 sc1
    s_mul_i32 s52, s48, 68
    s_mul_i32 s53, s3, 12
    s_add_u32 s53, s53, s52
    s_lshl_b32 s53, s53, 12
    s_add_u32 s83, s53, 10485760
    s_mul_i32 s53, s3, 5
    s_add_u32 s53, s53, s52
    s_add_u32 s53, s53, 48
    s_lshl_b32 s53, s53, 12
    s_add_u32 s84, s53, 10485760
    s_lshl_b32 s52, s48, 2
    s_add_u32 s52, s52, s3
    s_mul_i32 s52, s52, 20480
    s_mul_i32 s53, s49, 160
    s_add_u32 s85, s52, s53
    v_and_b32 v13, 15, v1
    v_mul_u32_u24 v13, 1280, v13
    v_lshrrev_b32 v15, 4, v1
    v_lshl_add_u32 v7, v15, 3, v13
    s_add_u32 s52, s3, 0
    s_and_b32 s52, s52, 3
    s_lshl_b32 s52, s52, 10
    v_add_u32 v9, s52, v2
    s_add_u32 s52, s3, 1
    s_and_b32 s52, s52, 3
    s_lshl_b32 s52, s52, 10
    v_add_u32 v10, s52, v2
    s_add_u32 s52, s3, 2
    s_and_b32 s52, s52, 3
    s_lshl_b32 s52, s52, 10
    v_add_u32 v11, s52, v2
    s_add_u32 s52, s3, 3
    s_and_b32 s52, s52, 3
    s_lshl_b32 s52, s52, 10
    v_add_u32 v12, s52, v2
    s_mul_i32 s52, s3, 15360
    s_add_u32 s52, s52, 0
    v_add_u32 v8, s52, v2
    v_mfma_f32_32x32x16_bf16 v[56:71], a[192:195], v[206:209], 0
    v_mfma_f32_32x32x16_bf16 v[56:71], a[196:199], v[210:213], v[56:71]
    v_mfma_f32_32x32x16_bf16 v[56:71], a[200:203], v[214:217], v[56:71]
    v_mfma_f32_32x32x16_bf16 v[72:87], a[204:207], v[206:209], 0
    v_mfma_f32_32x32x16_bf16 v[72:87], a[208:211], v[210:213], v[72:87]
    v_mfma_f32_32x32x16_bf16 v[72:87], a[212:215], v[214:217], v[72:87]
    s_nop 8
    v_max3_f32 v40, v56, v57, v58
    v_min3_f32 v41, v56, v57, v58
    v_max3_f32 v40, v40, v59, v60
    v_min3_f32 v41, v41, v59, v60
    v_max3_f32 v40, v40, v61, v62
    v_min3_f32 v41, v41, v61, v62
    v_max3_f32 v40, v40, v63, v64
    v_min3_f32 v41, v41, v63, v64
    v_max3_f32 v40, v40, v65, v66
    v_min3_f32 v41, v41, v65, v66
    v_max3_f32 v40, v40, v67, v68
    v_min3_f32 v41, v41, v67, v68
    v_max3_f32 v40, v40, v69, v70
    v_min3_f32 v41, v41, v69, v70
    v_max3_f32 v40, v40, v71, v72
    v_min3_f32 v41, v41, v71, v72
    v_max3_f32 v40, v40, v73, v74
    v_min3_f32 v41, v41, v73, v74
    v_max_f32 v40, v40, v75
    v_min_f32 v41, v41, v75
    v_mul_f32 v40, 1069066811, v40
    v_mul_f32 v41, 1069066811, v41
    s_mov_b32 s72, 1069066811
    v_pk_fma_f32 v[16:17], v[56:57], s[72:73], v[40:41] op_sel:[0,0,1] op_sel_hi:[1,0,1] neg_lo:[1,0,0] neg_hi:[1,0,0]
    v_pk_fma_f32 v[56:57], v[56:57], s[72:73], v[40:41] op_sel:[0,0,0] op_sel_hi:[1,0,0] neg_lo:[0,0,1] neg_hi:[0,0,1]
    v_pk_fma_f32 v[18:19], v[58:59], s[72:73], v[40:41] op_sel:[0,0,1] op_sel_hi:[1,0,1] neg_lo:[1,0,0] neg_hi:[1,0,0]
    v_pk_fma_f32 v[58:59], v[58:59], s[72:73], v[40:41] op_sel:[0,0,0] op_sel_hi:[1,0,0] neg_lo:[0,0,1] neg_hi:[0,0,1]
    v_pk_fma_f32 v[20:21], v[60:61], s[72:73], v[40:41] op_sel:[0,0,1] op_sel_hi:[1,0,1] neg_lo:[1,0,0] neg_hi:[1,0,0]
    v_pk_fma_f32 v[60:61], v[60:61], s[72:73], v[40:41] op_sel:[0,0,0] op_sel_hi:[1,0,0] neg_lo:[0,0,1] neg_hi:[0,0,1]
    v_pk_fma_f32 v[22:23], v[62:63], s[72:73], v[40:41] op_sel:[0,0,1] op_sel_hi:[1,0,1] neg_lo:[1,0,0] neg_hi:[1,0,0]
    v_pk_fma_f32 v[62:63], v[62:63], s[72:73], v[40:41] op_sel:[0,0,0] op_sel_hi:[1,0,0] neg_lo:[0,0,1] neg_hi:[0,0,1]
    v_pk_fma_f32 v[24:25], v[64:65], s[72:73], v[40:41] op_sel:[0,0,1] op_sel_hi:[1,0,1] neg_lo:[1,0,0] neg_hi:[1,0,0]
    v_pk_fma_f32 v[64:65], v[64:65], s[72:73], v[40:41] op_sel:[0,0,0] op_sel_hi:[1,0,0] neg_lo:[0,0,1] neg_hi:[0,0,1]
    v_pk_fma_f32 v[26:27], v[66:67], s[72:73], v[40:41] op_sel:[0,0,1] op_sel_hi:[1,0,1] neg_lo:[1,0,0] neg_hi:[1,0,0]
    v_pk_fma_f32 v[66:67], v[66:67], s[72:73], v[40:41] op_sel:[0,0,0] op_sel_hi:[1,0,0] neg_lo:[0,0,1] neg_hi:[0,0,1]
    v_pk_fma_f32 v[28:29], v[68:69], s[72:73], v[40:41] op_sel:[0,0,1] op_sel_hi:[1,0,1] neg_lo:[1,0,0] neg_hi:[1,0,0]
    v_pk_fma_f32 v[68:69], v[68:69], s[72:73], v[40:41] op_sel:[0,0,0] op_sel_hi:[1,0,0] neg_lo:[0,0,1] neg_hi:[0,0,1]
    v_pk_fma_f32 v[30:31], v[70:71], s[72:73], v[40:41] op_sel:[0,0,1] op_sel_hi:[1,0,1] neg_lo:[1,0,0] neg_hi:[1,0,0]
    v_pk_fma_f32 v[70:71], v[70:71], s[72:73], v[40:41] op_sel:[0,0,0] op_sel_hi:[1,0,0] neg_lo:[0,0,1] neg_hi:[0,0,1]
    v_pk_fma_f32 v[32:33], v[72:73], s[72:73], v[40:41] op_sel:[0,0,1] op_sel_hi:[1,0,1] neg_lo:[1,0,0] neg_hi:[1,0,0]
    v_pk_fma_f32 v[72:73], v[72:73], s[72:73], v[40:41] op_sel:[0,0,0] op_sel_hi:[1,0,0] neg_lo:[0,0,1] neg_hi:[0,0,1]
    v_pk_fma_f32 v[34:35], v[74:75], s[72:73], v[40:41] op_sel:[0,0,1] op_sel_hi:[1,0,1] neg_lo:[1,0,0] neg_hi:[1,0,0]
    v_pk_fma_f32 v[74:75], v[74:75], s[72:73], v[40:41] op_sel:[0,0,0] op_sel_hi:[1,0,0] neg_lo:[0,0,1] neg_hi:[0,0,1]
    v_exp_f32 v16, v16
    v_exp_f32 v56, v56
    v_exp_f32 v17, v17
    v_exp_f32 v57, v57
    v_exp_f32 v18, v18
    v_exp_f32 v58, v58
    v_exp_f32 v19, v19
    v_exp_f32 v59, v59
    v_exp_f32 v20, v20
    v_exp_f32 v60, v60
    v_exp_f32 v21, v21
    v_and_b32 v13, 3, v1
    v_lshlrev_b32 v13, 10, v13
    v_bfe_u32 v15, v1, 2, 1
    v_lshl_add_u32 v162, v15, 3, v13
    s_lshr_b32 s52, s48, 1
    s_and_b32 s53, s52, 7
    s_lshl_b32 s53, s53, 5
    s_lshr_b32 s52, s52, 3
    s_lshl_b32 s52, s52, 2
    s_add_u32 s52, s52, s53
    s_add_u32 s53, s3, 0
    s_and_b32 s53, s53, 3
    s_add_u32 s52, s52, s53
    s_lshl_b32 s52, s52, 7
    s_and_b32 s53, s48, 1
    s_lshl_b32 s53, s53, 4
    s_add_u32 s52, s52, s53
    s_add_u32 s99, s52, 167936
    s_waitcnt vmcnt(0)
    s_lshl_b32 s63, s2, 7
    s_lshl_b32 s62, s3, 3
    s_add_u32 s63, s63, s62
    s_add_u32 s63, s63, 167936
    buffer_store_dwordx2 v[4:5], v3, s[28:31], s63 offen sc1
    s_mul_i32 s74, s3, 31744
    s_add_u32 s74, s74, 0
    s_add_u32 s75, s51, 2
    s_and_b32 s75, s75, 3
    s_mul_i32 s75, s75, 15360
    s_add_u32 s75, s75, s81
    buffer_load_dwordx4 a[128:131], v2, s[28:31], s75 offen offset:2048 sc1
    v_exp_f32 v61, v61
    v_exp_f32 v22, v22
    v_exp_f32 v62, v62
    v_exp_f32 v23, v23
    v_exp_f32 v63, v63
    v_exp_f32 v24, v24
    v_exp_f32 v64, v64
    v_exp_f32 v25, v25
    v_exp_f32 v65, v65
    v_exp_f32 v26, v26
    v_exp_f32 v66, v66
    v_exp_f32 v27, v27
    buffer_load_dwordx4 a[132:135], v2, s[28:31], s75 offen offset:3072 sc1
    v_exp_f32 v67, v67
    v_exp_f32 v28, v28
    v_exp_f32 v68, v68
    v_exp_f32 v29, v29
    v_exp_f32 v69, v69
    v_exp_f32 v30, v30
    v_exp_f32 v70, v70
    v_exp_f32 v31, v31
    v_exp_f32 v71, v71
    v_exp_f32 v32, v32
    v_exp_f32 v72, v72
    v_exp_f32 v33, v33
    buffer_load_dwordx4 a[136:139], v0, s[28:31], s75 offen offset:0 sc1
    v_exp_f32 v73, v73
    v_exp_f32 v34, v34
    v_exp_f32 v74, v74
    v_exp_f32 v35, v35
    v_exp_f32 v75, v75
    v_pk_add_f32 v[42:43], v[56:57], v[58:59]
    v_pk_add_f32 v[44:45], v[16:17], v[18:19]
    v_pk_add_f32 v[42:43], v[42:43], v[60:61]
    v_pk_add_f32 v[44:45], v[44:45], v[20:21]
    v_pk_add_f32 v[42:43], v[42:43], v[62:63]
    v_pk_add_f32 v[44:45], v[44:45], v[22:23]
    v_pk_add_f32 v[42:43], v[42:43], v[64:65]
    s_add_u32 s75, s51, 2
    s_and_b32 s75, s75, 3
    s_mul_i32 s75, s75, 15360
    s_add_u32 s75, s75, s81
    s_add_u32 s75, s75, 5120
    buffer_load_dwordx4 a[140:143], v2, s[28:31], s75 offen offset:0 sc1
    v_pk_add_f32 v[44:45], v[44:45], v[24:25]
    v_pk_add_f32 v[42:43], v[42:43], v[66:67]
    v_pk_add_f32 v[44:45], v[44:45], v[26:27]
    v_pk_add_f32 v[42:43], v[42:43], v[68:69]
    v_pk_add_f32 v[44:45], v[44:45], v[28:29]
    v_pk_add_f32 v[42:43], v[42:43], v[70:71]
    v_pk_add_f32 v[44:45], v[44:45], v[30:31]
    v_pk_add_f32 v[42:43], v[42:43], v[72:73]
    v_pk_add_f32 v[44:45], v[44:45], v[32:33]
    v_pk_add_f32 v[42:43], v[42:43], v[74:75]
    v_pk_add_f32 v[44:45], v[44:45], v[34:35]
    v_add_f32 v42, v42, v43
    buffer_load_dwordx4 a[144:147], v2, s[28:31], s75 offen offset:1024 sc1
    v_add_f32 v44, v44, v45
    v_rcp_f32 v42, v42
    v_rcp_f32 v44, v44
    v_pk_mul_f32 v[56:57], v[56:57], v[42:43] op_sel:[0,0] op_sel_hi:[1,0]
    v_cvt_pk_bf16_f32 v172, v56, v57
    v_pk_mul_f32 v[58:59], v[58:59], v[42:43] op_sel:[0,0] op_sel_hi:[1,0]
    v_cvt_pk_bf16_f32 v173, v58, v59
    v_pk_mul_f32 v[60:61], v[60:61], v[42:43] op_sel:[0,0] op_sel_hi:[1,0]
    v_cvt_pk_bf16_f32 v174, v60, v61
    v_pk_mul_f32 v[62:63], v[62:63], v[42:43] op_sel:[0,0] op_sel_hi:[1,0]
    v_cvt_pk_bf16_f32 v175, v62, v63
    v_pk_mul_f32 v[64:65], v[64:65], v[42:43] op_sel:[0,0] op_sel_hi:[1,0]
    buffer_load_dwordx4 a[148:151], v2, s[28:31], s75 offen offset:2048 sc1
    v_cvt_pk_bf16_f32 v176, v64, v65
    v_pk_mul_f32 v[66:67], v[66:67], v[42:43] op_sel:[0,0] op_sel_hi:[1,0]
    v_cvt_pk_bf16_f32 v177, v66, v67
    v_pk_mul_f32 v[68:69], v[68:69], v[42:43] op_sel:[0,0] op_sel_hi:[1,0]
    v_cvt_pk_bf16_f32 v178, v68, v69
    v_pk_mul_f32 v[70:71], v[70:71], v[42:43] op_sel:[0,0] op_sel_hi:[1,0]
    v_cvt_pk_bf16_f32 v179, v70, v71
    v_pk_mul_f32 v[72:73], v[72:73], v[42:43] op_sel:[0,0] op_sel_hi:[1,0]
    v_cvt_pk_bf16_f32 v180, v72, v73
    v_pk_mul_f32 v[74:75], v[74:75], v[42:43] op_sel:[0,0] op_sel_hi:[1,0]
    v_cvt_pk_bf16_f32 v181, v74, v75
    v_pk_mul_f32 v[16:17], v[16:17], v[44:45] op_sel:[0,0] op_sel_hi:[1,0]
    buffer_load_dwordx4 a[152:155], v2, s[28:31], s75 offen offset:3072 sc1
    v_cvt_pk_bf16_f32 v182, v16, v17
    v_pk_mul_f32 v[18:19], v[18:19], v[44:45] op_sel:[0,0] op_sel_hi:[1,0]
    v_cvt_pk_bf16_f32 v183, v18, v19
    v_pk_mul_f32 v[20:21], v[20:21], v[44:45] op_sel:[0,0] op_sel_hi:[1,0]
    v_cvt_pk_bf16_f32 v184, v20, v21
    v_pk_mul_f32 v[22:23], v[22:23], v[44:45] op_sel:[0,0] op_sel_hi:[1,0]
    v_cvt_pk_bf16_f32 v185, v22, v23
    v_pk_mul_f32 v[24:25], v[24:25], v[44:45] op_sel:[0,0] op_sel_hi:[1,0]
    v_cvt_pk_bf16_f32 v186, v24, v25
    v_pk_mul_f32 v[26:27], v[26:27], v[44:45] op_sel:[0,0] op_sel_hi:[1,0]
    v_cvt_pk_bf16_f32 v187, v26, v27
    v_pk_mul_f32 v[28:29], v[28:29], v[44:45] op_sel:[0,0] op_sel_hi:[1,0]
    buffer_load_dwordx4 a[156:159], v0, s[28:31], s75 offen offset:0 sc1
    v_cvt_pk_bf16_f32 v188, v28, v29
    v_pk_mul_f32 v[30:31], v[30:31], v[44:45] op_sel:[0,0] op_sel_hi:[1,0]
    v_cvt_pk_bf16_f32 v189, v30, v31
    v_pk_mul_f32 v[32:33], v[32:33], v[44:45] op_sel:[0,0] op_sel_hi:[1,0]
    v_cvt_pk_bf16_f32 v190, v32, v33
    v_pk_mul_f32 v[34:35], v[34:35], v[44:45] op_sel:[0,0] op_sel_hi:[1,0]
    v_cvt_pk_bf16_f32 v191, v34, v35
    v_and_b32 v236, 31, v1
    v_lshrrev_b32 v237, 5, v1
    v_bfe_u32 v238, v236, 2, 1
    v_lshrrev_b32 v239, 3, v236
    v_and_b32 v240, 3, v236
    buffer_load_dwordx2 v[170:171], v14, s[28:31], s65 offen sc1
    v_lshl_add_u32 v239, v239, 2, v240
    v_mul_u32_u24 v241, 1680, v237
    v_add_u32 v241, 131072, v241
    v_mov_b32 v242, 162880
    v_add_u32 v243, 0, v239
    v_mul_u32_u24 v228, 80, v243
    v_add_u32 v228, v228, v241
    v_cmp_eq_u32 vcc, v237, v238
    s_nop 1
    v_cndmask_b32 v228, v242, v228, vcc
    v_cmp_gt_u32 vcc, 21, v243
    s_nop 1
    v_cndmask_b32 v228, v242, v228, vcc
    v_add_u32 v243, 16, v239
    s_add_u32 s75, s51, 2
    s_and_b32 s75, s75, 3
    s_mul_i32 s75, s75, 15360
    s_add_u32 s75, s75, s81
    s_add_u32 s75, s75, 10240
    buffer_load_dwordx4 a[160:163], v2, s[28:31], s75 offen offset:0 sc1
    v_mul_u32_u24 v229, 80, v243
    v_add_u32 v229, v229, v241
    v_cmp_eq_u32 vcc, v237, v238
    s_nop 1
    v_cndmask_b32 v229, v242, v229, vcc
    v_cmp_gt_u32 vcc, 21, v243
    s_nop 1
    v_cndmask_b32 v229, v242, v229, vcc
    s_mul_i32 s52, s47, 5
    s_add_u32 s52, s52, 0
    s_lshr_b32 s53, s52, 2
    s_add_u32 s53, s53, 48
    s_lshl_b32 s53, s53, 12
    s_and_b32 s52, s52, 3
    buffer_load_dwordx4 a[164:167], v2, s[28:31], s75 offen offset:1024 sc1
    s_lshl_b32 s52, s52, 8
    s_add_u32 s54, s52, s53
    s_mul_i32 s52, s47, 5
    s_add_u32 s52, s52, 1
    s_lshr_b32 s53, s52, 2
    s_add_u32 s53, s53, 48
    s_lshl_b32 s53, s53, 12
    s_and_b32 s52, s52, 3
    s_lshl_b32 s52, s52, 8
    s_add_u32 s55, s52, s53
    s_mul_i32 s52, s47, 5
    s_add_u32 s52, s52, 2
    buffer_load_dwordx4 a[168:171], v2, s[28:31], s75 offen offset:2048 sc1
    s_lshr_b32 s53, s52, 2
    s_add_u32 s53, s53, 48
    s_lshl_b32 s53, s53, 12
    s_and_b32 s52, s52, 3
    s_lshl_b32 s52, s52, 8
    s_add_u32 s56, s52, s53
    s_mul_i32 s52, s47, 5
    s_add_u32 s52, s52, 3
    s_lshr_b32 s53, s52, 2
    s_add_u32 s53, s53, 48
    s_lshl_b32 s53, s53, 12
    s_and_b32 s52, s52, 3
    buffer_load_dwordx4 a[172:175], v2, s[28:31], s75 offen offset:3072 sc1
    s_lshl_b32 s52, s52, 8
    s_add_u32 s57, s52, s53
    s_mul_i32 s52, s47, 5
    s_add_u32 s52, s52, 4
    s_lshr_b32 s53, s52, 2
    s_add_u32 s53, s53, 48
    s_lshl_b32 s53, s53, 12
    s_and_b32 s52, s52, 3
    s_lshl_b32 s52, s52, 8
    s_add_u32 s58, s52, s53
    v_lshrrev_b32 v237, 4, v236
    v_lshlrev_b32 v237, 10, v237
    buffer_load_dwordx4 a[176:179], v0, s[28:31], s75 offen offset:0 sc1
    v_and_b32 v236, 15, v236
    v_lshl_add_u32 v236, v236, 4, v237
    v_cmp_gt_u32 vcc, 32, v1
    v_mov_b32 v238, s56
    v_mov_b32 v239, s54
    v_cndmask_b32 v238, v238, v239, vcc
    v_add_u32 v230, v236, v238
    v_mov_b32 v238, s57
    v_mov_b32 v239, s55
    v_cndmask_b32 v238, v238, v239, vcc
    v_add_u32 v231, v236, v238
    v_mov_b32 v238, 1073741824
    s_add_u32 s75, s51, 3
    s_and_b32 s75, s75, 3
    s_mul_i32 s75, s75, 15360
    s_add_u32 s75, s75, s81
    buffer_load_dwordx4 a[180:183], v2, s[28:31], s75 offen offset:0 sc1
    v_add_u32 v239, s58, v236
    v_cndmask_b32 v232, v238, v239, vcc
    s_waitcnt vmcnt(6)
    v_cmp_ne_u64 vcc, s[44:45], v[170:171]
    s_nop 0
    s_cbranch_vccnz L_slow_20
L_back_21:
    s_mul_i32 s72, s3, 53
    v_add_u32 v233, s72, v1
    v_cmp_gt_u32 vcc, 210, v233
    v_lshlrev_b32 v233, 4, v233
    v_mov_b32 v168, 1073741824
    v_cndmask_b32 v233, v168, v233, vcc
    v_cmp_gt_u32 vcc, 53, v1
    s_nop 1
    v_cndmask_b32 v233, v168, v233, vcc
    s_mul_i32 s72, s47, 55296
    s_add_u32 s72, s72, 19922944
    buffer_load_dwordx4 v[192:195], v233, s[28:31], s72 offen sc1
    s_add_u32 s72, s72, 3456
    buffer_load_dwordx4 v[196:199], v233, s[28:31], s72 offen sc1
    s_add_u32 s72, s72, 3456
    buffer_load_dwordx4 v[200:203], v233, s[28:31], s72 offen sc1
    s_add_u32 s72, s72, 3456
    buffer_load_dwordx4 v[204:207], v233, s[28:31], s72 offen sc1
    s_add_u32 s72, s72, 3456
    buffer_load_dwordx4 v[208:211], v233, s[28:31], s72 offen sc1
    s_add_u32 s72, s72, 3456
    buffer_load_dwordx4 v[212:215], v233, s[28:31], s72 offen sc1
    s_add_u32 s72, s72, 3456
    buffer_load_dwordx4 v[216:219], v233, s[28:31], s72 offen sc1
    s_add_u32 s72, s72, 3456
    buffer_load_dwordx4 v[220:223], v233, s[28:31], s72 offen sc1
    s_add_u32 s72, s72, 3456
    buffer_load_dwordx4 v[224:227], v233, s[28:31], s72 offen sc1
    s_add_u32 s72, s72, 3456
    buffer_load_dwordx4 v[236:239], v233, s[28:31], s72 offen sc1
    s_add_u32 s72, s72, 3456
    buffer_load_dwordx4 v[240:243], v233, s[28:31], s72 offen sc1
    s_add_u32 s72, s72, 3456
    buffer_load_dwordx4 v[244:247], v233, s[28:31], s72 offen sc1
    s_add_u32 s72, s72, 3456
    buffer_load_dwordx4 v[248:251], v233, s[28:31], s72 offen sc1
    s_add_u32 s72, s72, 3456
    buffer_load_dwordx4 v[252:255], v233, s[28:31], s72 offen sc1
    s_add_u32 s72, s72, 3456
    buffer_load_dwordx4 v[152:155], v233, s[28:31], s72 offen sc1
    s_add_u32 s72, s72, 3456
    buffer_load_dwordx4 v[156:159], v233, s[28:31], s72 offen sc1
    buffer_load_dwordx4 a[184:187], v2, s[28:31], s75 offen offset:1024 sc1
    buffer_load_dwordx4 a[188:191], v2, s[28:31], s75 offen offset:2048 sc1
    s_add_u32 s75, s51, 3
    s_and_b32 s75, s75, 3
    s_mul_i32 s75, s75, 15360
    s_add_u32 s75, s75, s81
    buffer_load_dwordx4 a[192:195], v2, s[28:31], s75 offen offset:3072 sc1
    buffer_load_dwordx4 a[196:199], v0, s[28:31], s75 offen offset:0 sc1
    s_add_u32 s75, s51, 3
    s_and_b32 s75, s75, 3
    s_mul_i32 s75, s75, 15360
    s_add_u32 s75, s75, s81
    s_add_u32 s75, s75, 5120
    buffer_load_dwordx4 a[200:203], v2, s[28:31], s75 offen offset:0 sc1
    buffer_load_dwordx4 a[204:207], v2, s[28:31], s75 offen offset:1024 sc1
    buffer_load_dwordx4 a[208:211], v2, s[28:31], s75 offen offset:2048 sc1
    buffer_load_dwordx4 a[212:215], v2, s[28:31], s75 offen offset:3072 sc1
    s_mov_b32 s96, 0x00003f80
    s_mov_b32 s97, 0x3f800000
    s_waitcnt vmcnt(23)
    v_lshlrev_b32 v144, 16, v192
    v_and_b32 v145, 0xffff0000, v192
    v_lshlrev_b32 v146, 16, v193
    v_and_b32 v147, 0xffff0000, v193
    v_lshlrev_b32 v148, 16, v194
    v_and_b32 v149, 0xffff0000, v194
    v_lshlrev_b32 v150, 16, v195
    v_and_b32 v151, 0xffff0000, v195
    s_waitcnt vmcnt(22)
    v_dot2_f32_bf16 v144, v196, s96, v144
    v_dot2_f32_bf16 v145, v196, s97, v145
    v_dot2_f32_bf16 v146, v197, s96, v146
    v_dot2_f32_bf16 v147, v197, s97, v147
    v_dot2_f32_bf16 v148, v198, s96, v148
    v_dot2_f32_bf16 v149, v198, s97, v149
    v_dot2_f32_bf16 v150, v199, s96, v150
    v_dot2_f32_bf16 v151, v199, s97, v151
    s_waitcnt vmcnt(21)
    v_dot2_f32_bf16 v144, v200, s96, v144
    v_dot2_f32_bf16 v145, v200, s97, v145
    v_dot2_f32_bf16 v146, v201, s96, v146
    v_dot2_f32_bf16 v147, v201, s97, v147
    v_dot2_f32_bf16 v148, v202, s96, v148
    v_dot2_f32_bf16 v149, v202, s97, v149
    v_dot2_f32_bf16 v150, v203, s96, v150
    v_dot2_f32_bf16 v151, v203, s97, v151
    s_waitcnt vmcnt(20)
    v_dot2_f32_bf16 v144, v204, s96, v144
    v_dot2_f32_bf16 v145, v204, s97, v145
    v_dot2_f32_bf16 v146, v205, s96, v146
    v_dot2_f32_bf16 v147, v205, s97, v147
    v_dot2_f32_bf16 v148, v206, s96, v148
    v_dot2_f32_bf16 v149, v206, s97, v149
    v_dot2_f32_bf16 v150, v207, s96, v150
    v_dot2_f32_bf16 v151, v207, s97, v151
    s_waitcnt vmcnt(19)
    v_dot2_f32_bf16 v144, v208, s96, v144
    v_dot2_f32_bf16 v145, v208, s97, v145
    v_dot2_f32_bf16 v146, v209, s96, v146
    v_dot2_f32_bf16 v147, v209, s97, v147
    v_dot2_f32_bf16 v148, v210, s96, v148
    v_dot2_f32_bf16 v149, v210, s97, v149
    buffer_load_dwordx2 v[164:165], v162, s[28:31], s99 offen sc1
    v_dot2_f32_bf16 v150, v211, s96, v150
    v_dot2_f32_bf16 v151, v211, s97, v151
    s_waitcnt vmcnt(19)
    v_dot2_f32_bf16 v144, v212, s96, v144
    v_dot2_f32_bf16 v145, v212, s97, v145
    v_dot2_f32_bf16 v146, v213, s96, v146
    v_dot2_f32_bf16 v147, v213, s97, v147
    v_dot2_f32_bf16 v148, v214, s96, v148
    v_dot2_f32_bf16 v149, v214, s97, v149
    v_dot2_f32_bf16 v150, v215, s96, v150
    v_dot2_f32_bf16 v151, v215, s97, v151
    s_waitcnt vmcnt(18)
    v_dot2_f32_bf16 v144, v216, s96, v144
    v_dot2_f32_bf16 v145, v216, s97, v145
    v_dot2_f32_bf16 v146, v217, s96, v146
    v_dot2_f32_bf16 v147, v217, s97, v147
    v_dot2_f32_bf16 v148, v218, s96, v148
    v_dot2_f32_bf16 v149, v218, s97, v149
    v_dot2_f32_bf16 v150, v219, s96, v150
    v_dot2_f32_bf16 v151, v219, s97, v151
    s_waitcnt vmcnt(17)
    v_dot2_f32_bf16 v144, v220, s96, v144
    v_dot2_f32_bf16 v145, v220, s97, v145
    v_dot2_f32_bf16 v146, v221, s96, v146
    v_dot2_f32_bf16 v147, v221, s97, v147
    v_dot2_f32_bf16 v148, v222, s96, v148
    v_dot2_f32_bf16 v149, v222, s97, v149
    v_dot2_f32_bf16 v150, v223, s96, v150
    v_dot2_f32_bf16 v151, v223, s97, v151
    s_waitcnt vmcnt(16)
    v_dot2_f32_bf16 v144, v224, s96, v144
    v_dot2_f32_bf16 v145, v224, s97, v145
    v_dot2_f32_bf16 v146, v225, s96, v146
    v_dot2_f32_bf16 v147, v225, s97, v147
    v_dot2_f32_bf16 v148, v226, s96, v148
    v_dot2_f32_bf16 v149, v226, s97, v149
    v_dot2_f32_bf16 v150, v227, s96, v150
    v_dot2_f32_bf16 v151, v227, s97, v151
    s_waitcnt vmcnt(15)
    v_dot2_f32_bf16 v144, v236, s96, v144
    v_dot2_f32_bf16 v145, v236, s97, v145
    v_dot2_f32_bf16 v146, v237, s96, v146
    v_dot2_f32_bf16 v147, v237, s97, v147
    v_dot2_f32_bf16 v148, v238, s96, v148
    v_dot2_f32_bf16 v149, v238, s97, v149
    v_dot2_f32_bf16 v150, v239, s96, v150
    v_dot2_f32_bf16 v151, v239, s97, v151
    s_waitcnt vmcnt(14)
    v_dot2_f32_bf16 v144, v240, s96, v144
    v_dot2_f32_bf16 v145, v240, s97, v145
    v_dot2_f32_bf16 v146, v241, s96, v146
    v_dot2_f32_bf16 v147, v241, s97, v147
    v_dot2_f32_bf16 v148, v242, s96, v148
    v_dot2_f32_bf16 v149, v242, s97, v149
    v_dot2_f32_bf16 v150, v243, s96, v150
    v_dot2_f32_bf16 v151, v243, s97, v151
    s_waitcnt vmcnt(13)
    v_dot2_f32_bf16 v144, v244, s96, v144
    v_dot2_f32_bf16 v145, v244, s97, v145
    v_dot2_f32_bf16 v146, v245, s96, v146
    v_dot2_f32_bf16 v147, v245, s97, v147
    v_dot2_f32_bf16 v148, v246, s96, v148
    v_dot2_f32_bf16 v149, v246, s97, v149
    v_dot2_f32_bf16 v150, v247, s96, v150
    v_dot2_f32_bf16 v151, v247, s97, v151
    s_waitcnt vmcnt(12)
    v_dot2_f32_bf16 v144, v248, s96, v144
    v_dot2_f32_bf16 v145, v248, s97, v145
    v_dot2_f32_bf16 v146, v249, s96, v146
    v_dot2_f32_bf16 v147, v249, s97, v147
    v_dot2_f32_bf16 v148, v250, s96, v148
    v_dot2_f32_bf16 v149, v250, s97, v149
    v_dot2_f32_bf16 v150, v251, s96, v150
    v_dot2_f32_bf16 v151, v251, s97, v151
    s_waitcnt vmcnt(11)
    v_dot2_f32_bf16 v144, v252, s96, v144
    v_dot2_f32_bf16 v145, v252, s97, v145
    v_dot2_f32_bf16 v146, v253, s96, v146
    v_dot2_f32_bf16 v147, v253, s97, v147
    v_dot2_f32_bf16 v148, v254, s96, v148
    v_dot2_f32_bf16 v149, v254, s97, v149
    v_dot2_f32_bf16 v150, v255, s96, v150
    v_dot2_f32_bf16 v151, v255, s97, v151
    s_waitcnt vmcnt(10)
    v_dot2_f32_bf16 v144, v152, s96, v144
    v_dot2_f32_bf16 v145, v152, s97, v145
    v_dot2_f32_bf16 v146, v153, s96, v146
    v_dot2_f32_bf16 v147, v153, s97, v147
    v_dot2_f32_bf16 v148, v154, s96, v148
    v_dot2_f32_bf16 v149, v154, s97, v149
    v_dot2_f32_bf16 v150, v155, s96, v150
    v_dot2_f32_bf16 v151, v155, s97, v151
    s_waitcnt vmcnt(9)
    v_dot2_f32_bf16 v144, v156, s96, v144
    v_dot2_f32_bf16 v145, v156, s97, v145
    v_dot2_f32_bf16 v146, v157, s96, v146
    v_dot2_f32_bf16 v147, v157, s97, v147
    v_dot2_f32_bf16 v148, v158, s96, v148
    v_dot2_f32_bf16 v149, v158, s97, v149
    v_dot2_f32_bf16 v150, v159, s96, v150
    v_dot2_f32_bf16 v151, v159, s97, v151
    s_waitcnt vmcnt(0)
    v_cmp_ne_u64 vcc, s[44:45], v[164:165]
    s_nop 0
    s_cbranch_vccnz L_slow_24
L_back_25:
    s_add_u32 s73, s51, 0
    s_and_b32 s73, s73, 3
    s_mul_i32 s73, s73, 12288
    s_add_u32 s73, s73, s83
    buffer_load_dwordx4 v[96:99], v9, s[28:31], s73 offen sc1
    buffer_load_dwordx4 v[100:103], v10, s[28:31], s73 offen sc1
    buffer_load_dwordx4 v[104:107], v11, s[28:31], s73 offen sc1
    buffer_load_dwordx4 v[108:111], v12, s[28:31], s73 offen sc1
    s_add_u32 s73, s73, 4096
    buffer_load_dwordx4 v[112:115], v9, s[28:31], s73 offen sc1
    buffer_load_dwordx4 v[116:119], v10, s[28:31], s73 offen sc1
    buffer_load_dwordx4 v[120:123], v11, s[28:31], s73 offen sc1
    buffer_load_dwordx4 v[124:127], v12, s[28:31], s73 offen sc1
    s_add_u32 s73, s73, 4096
    buffer_load_dwordx4 v[128:131], v9, s[28:31], s73 offen sc1
    buffer_load_dwordx4 v[132:135], v10, s[28:31], s73 offen sc1
    buffer_load_dwordx4 v[136:139], v11, s[28:31], s73 offen sc1
    buffer_load_dwordx4 v[140:143], v12, s[28:31], s73 offen sc1
    s_mul_i32 s72, s3, 53
    v_add_u32 v233, s72, v1
    v_cmp_gt_u32 vcc, 210, v233
    v_lshlrev_b32 v233, 4, v233
    v_mov_b32 v168, 4096
    v_cndmask_b32 v233, v168, v233, vcc
    v_cmp_gt_u32 vcc, 53, v1
    s_nop 1
    v_cndmask_b32 v233, v168, v233, vcc
    v_add_u32 v233, 131072, v233
    v_cvt_pk_bf16_f32 v144, v144, v145
    v_cvt_pk_bf16_f32 v145, v146, v147
    v_cvt_pk_bf16_f32 v146, v148, v149
    v_cvt_pk_bf16_f32 v147, v150, v151
    ds_write_b128 v233, v[144:147]
    s_waitcnt lgkmcnt(0)
    s_barrier
    ds_read_b128 a[216:219], v228 offset:0
    ds_read_b128 a[220:223], v228 offset:16
    ds_read_b128 a[224:227], v228 offset:32
    ds_read_b128 a[228:231], v228 offset:48
    ds_read_b128 a[232:235], v228 offset:64
    ds_read_b128 a[236:239], v229 offset:0
    ds_read_b128 a[240:243], v229 offset:16
    ds_read_b128 a[244:247], v229 offset:32
    ds_read_b128 a[248:251], v229 offset:48
    ds_read_b128 a[252:255], v229 offset:64
    s_add_u32 s73, s51, 1
    s_and_b32 s73, s73, 3
    s_branch L_padskip4
.p2align 12
L_pad4:
    s_setpc_b64 s[62:63]
L_padskip4:
    s_mul_i32 s73, s73, 12288
    s_add_u32 s73, s73, s83
    buffer_load_dwordx4 v[144:147], v9, s[28:31], s73 offen sc1
    buffer_load_dwordx4 v[148:151], v10, s[28:31], s73 offen sc1
    buffer_load_dwordx4 v[152:155], v11, s[28:31], s73 offen sc1
    buffer_load_dwordx4 v[156:159], v12, s[28:31], s73 offen sc1
    s_waitcnt vmcnt(15)
    v_mfma_f32_16x16x32_bf16 v[16:19], a[0:3], v[96:99], 0
    v_mfma_f32_16x16x32_bf16 v[20:23], a[4:7], v[96:99], 0
    v_mfma_f32_16x16x32_bf16 v[24:27], a[8:11], v[96:99], 0
    v_mfma_f32_16x16x32_bf16 v[28:31], a[12:15], v[96:99], 0
    v_mfma_f32_16x16x32_bf16 v[32:35], a[16:19], v[96:99], 0
    s_waitcnt lgkmcnt(9)
    v_mfma_f32_32x32x16_bf16 v[192:207], a[216:219], v[172:175], 0
    s_waitcnt lgkmcnt(8)
    v_mfma_f32_32x32x16_bf16 v[192:207], a[220:223], v[176:179], v[192:207]
    s_waitcnt lgkmcnt(7)
    v_mfma_f32_32x32x16_bf16 v[192:207], a[224:227], v[180:183], v[192:207]
    s_waitcnt lgkmcnt(6)
    v_mfma_f32_32x32x16_bf16 v[192:207], a[228:231], v[184:187], v[192:207]
    s_waitcnt lgkmcnt(5)
    v_mfma_f32_32x32x16_bf16 v[192:207], a[232:235], v[188:191], v[192:207]
    s_waitcnt lgkmcnt(4)
    v_mfma_f32_32x32x16_bf16 v[208:223], a[236:239], v[172:175], 0
    s_waitcnt lgkmcnt(3)
    v_mfma_f32_32x32x16_bf16 v[208:223], a[240:243], v[176:179], v[208:223]
    s_waitcnt lgkmcnt(2)
    v_mfma_f32_32x32x16_bf16 v[208:223], a[244:247], v[180:183], v[208:223]
    s_waitcnt lgkmcnt(1)
    v_mfma_f32_32x32x16_bf16 v[208:223], a[248:251], v[184:187], v[208:223]
    s_waitcnt lgkmcnt(0)
    v_mfma_f32_32x32x16_bf16 v[208:223], a[252:255], v[188:191], v[208:223]
    s_add_u32 s73, s73, 4096
    buffer_load_dwordx4 v[96:99], v9, s[28:31], s73 offen sc1
    s_waitcnt vmcnt(15)
    v_mfma_f32_16x16x32_bf16 v[36:39], a[0:3], v[100:103], 0
    v_mfma_f32_16x16x32_bf16 v[40:43], a[4:7], v[100:103], 0
    v_mfma_f32_16x16x32_bf16 v[44:47], a[8:11], v[100:103], 0
    v_mfma_f32_16x16x32_bf16 v[48:51], a[12:15], v[100:103], 0
    v_mfma_f32_16x16x32_bf16 v[52:55], a[16:19], v[100:103], 0
    buffer_load_dwordx4 v[100:103], v10, s[28:31], s73 offen sc1
    s_waitcnt vmcnt(15)
    v_mfma_f32_16x16x32_bf16 v[56:59], a[0:3], v[104:107], 0
    v_mfma_f32_16x16x32_bf16 v[60:63], a[4:7], v[104:107], 0
    v_mfma_f32_16x16x32_bf16 v[64:67], a[8:11], v[104:107], 0
    v_mfma_f32_16x16x32_bf16 v[68:71], a[12:15], v[104:107], 0
    v_mfma_f32_16x16x32_bf16 v[72:75], a[16:19], v[104:107], 0
    buffer_load_dwordx4 v[104:107], v11, s[28:31], s73 offen sc1
    s_waitcnt vmcnt(15)
    v_mfma_f32_16x16x32_bf16 v[76:79], a[0:3], v[108:111], 0
    v_mfma_f32_16x16x32_bf16 v[80:83], a[4:7], v[108:111], 0
    v_mfma_f32_16x16x32_bf16 v[84:87], a[8:11], v[108:111], 0
    v_mfma_f32_16x16x32_bf16 v[88:91], a[12:15], v[108:111], 0
    v_mfma_f32_16x16x32_bf16 v[92:95], a[16:19], v[108:111], 0
    v_add_f32 v212, 0x358637bd, v212
    v_rcp_f32 v212, v212
    s_nop 0
    v_pk_mul_f32 v[192:193], v[192:193], v[212:213] op_sel:[0,0] op_sel_hi:[1,0]
    v_cvt_pk_bf16_f32 v234, v192, v193
    v_pk_mul_f32 v[194:195], v[194:195], v[212:213] op_sel:[0,0] op_sel_hi:[1,0]
    v_cvt_pk_bf16_f32 v235, v194, v195
    v_pk_mul_f32 v[196:197], v[196:197], v[212:213] op_sel:[0,0] op_sel_hi:[1,0]
    v_cvt_pk_bf16_f32 v236, v196, v197
    v_pk_mul_f32 v[198:199], v[198:199], v[212:213] op_sel:[0,0] op_sel_hi:[1,0]
    v_cvt_pk_bf16_f32 v237, v198, v199
    v_pk_mul_f32 v[200:201], v[200:201], v[212:213] op_sel:[0,0] op_sel_hi:[1,0]
    v_cvt_pk_bf16_f32 v238, v200, v201
    v_pk_mul_f32 v[202:203], v[202:203], v[212:213] op_sel:[0,0] op_sel_hi:[1,0]
    v_cvt_pk_bf16_f32 v239, v202, v203
    v_pk_mul_f32 v[204:205], v[204:205], v[212:213] op_sel:[0,0] op_sel_hi:[1,0]
    v_cvt_pk_bf16_f32 v240, v204, v205
    v_pk_mul_f32 v[206:207], v[206:207], v[212:213] op_sel:[0,0] op_sel_hi:[1,0]
    v_cvt_pk_bf16_f32 v241, v206, v207
    v_pk_mul_f32 v[208:209], v[208:209], v[212:213] op_sel:[0,0] op_sel_hi:[1,0]
    v_cvt_pk_bf16_f32 v242, v208, v209
    v_pk_mul_f32 v[210:211], v[210:211], v[212:213] op_sel:[0,0] op_sel_hi:[1,0]
    v_cvt_pk_bf16_f32 v243, v210, v211
    v_mov_b32 v244, 0
    v_mov_b32 v245, 0
    s_nop 0
    v_permlane32_swap_b32 v242, v244
    v_permlane32_swap_b32 v243, v245
    buffer_store_dwordx4 v[234:237], v230, s[28:31], s80 offen sc1
    buffer_store_dwordx4 v[238:241], v231, s[28:31], s80 offen sc1
    buffer_store_dwordx4 v[242:245], v232, s[28:31], s80 offen sc1
    buffer_load_dwordx4 v[108:111], v12, s[28:31], s73 offen sc1
    s_waitcnt vmcnt(18)
    v_mfma_f32_16x16x32_bf16 v[16:19], a[20:23], v[112:115], v[16:19]
    v_mfma_f32_16x16x32_bf16 v[20:23], a[24:27], v[112:115], v[20:23]
    v_mfma_f32_16x16x32_bf16 v[24:27], a[28:31], v[112:115], v[24:27]
    v_mfma_f32_16x16x32_bf16 v[28:31], a[32:35], v[112:115], v[28:31]
    v_mfma_f32_16x16x32_bf16 v[32:35], a[36:39], v[112:115], v[32:35]
    s_add_u32 s73, s73, 4096
    buffer_load_dwordx4 v[112:115], v9, s[28:31], s73 offen sc1
    s_waitcnt vmcnt(18)
    v_mfma_f32_16x16x32_bf16 v[36:39], a[20:23], v[116:119], v[36:39]
    v_mfma_f32_16x16x32_bf16 v[40:43], a[24:27], v[116:119], v[40:43]
    v_mfma_f32_16x16x32_bf16 v[44:47], a[28:31], v[116:119], v[44:47]
    v_mfma_f32_16x16x32_bf16 v[48:51], a[32:35], v[116:119], v[48:51]
    v_mfma_f32_16x16x32_bf16 v[52:55], a[36:39], v[116:119], v[52:55]
    s_add_u32 s75, s51, 3
    s_and_b32 s75, s75, 3
    s_mul_i32 s75, s75, 15360
    s_add_u32 s75, s75, s81
    s_add_u32 s75, s75, 5120
    buffer_load_dwordx4 a[216:219], v0, s[28:31], s75 offen offset:0 sc1
    buffer_load_dwordx4 v[116:119], v10, s[28:31], s73 offen sc1
    s_waitcnt vmcnt(19)
    v_mfma_f32_16x16x32_bf16 v[56:59], a[20:23], v[120:123], v[56:59]
    v_mfma_f32_16x16x32_bf16 v[60:63], a[24:27], v[120:123], v[60:63]
    v_mfma_f32_16x16x32_bf16 v[64:67], a[28:31], v[120:123], v[64:67]
    v_mfma_f32_16x16x32_bf16 v[68:71], a[32:35], v[120:123], v[68:71]
    v_mfma_f32_16x16x32_bf16 v[72:75], a[36:39], v[120:123], v[72:75]
    s_add_u32 s75, s51, 3
    s_and_b32 s75, s75, 3
    s_mul_i32 s75, s75, 15360
    s_add_u32 s75, s75, s81
    s_add_u32 s75, s75, 10240
    buffer_load_dwordx4 a[220:223], v2, s[28:31], s75 offen offset:0 sc1
    buffer_load_dwordx4 v[120:123], v11, s[28:31], s73 offen sc1
    s_waitcnt vmcnt(20)
    v_mfma_f32_16x16x32_bf16 v[76:79], a[20:23], v[124:127], v[76:79]
    v_mfma_f32_16x16x32_bf16 v[80:83], a[24:27], v[124:127], v[80:83]
    v_mfma_f32_16x16x32_bf16 v[84:87], a[28:31], v[124:127], v[84:87]
    v_mfma_f32_16x16x32_bf16 v[88:91], a[32:35], v[124:127], v[88:91]
    v_mfma_f32_16x16x32_bf16 v[92:95], a[36:39], v[124:127], v[92:95]
    buffer_load_dwordx4 a[224:227], v2, s[28:31], s75 offen offset:1024 sc1
    buffer_load_dwordx4 v[124:127], v12, s[28:31], s73 offen sc1
    s_waitcnt vmcnt(21)
    v_mfma_f32_16x16x32_bf16 v[16:19], a[40:43], v[128:131], v[16:19]
    v_mfma_f32_16x16x32_bf16 v[20:23], a[44:47], v[128:131], v[20:23]
    v_mfma_f32_16x16x32_bf16 v[24:27], a[48:51], v[128:131], v[24:27]
    v_mfma_f32_16x16x32_bf16 v[28:31], a[52:55], v[128:131], v[28:31]
    v_mfma_f32_16x16x32_bf16 v[32:35], a[56:59], v[128:131], v[32:35]
    buffer_load_dwordx4 a[228:231], v2, s[28:31], s75 offen offset:2048 sc1
    s_add_u32 s73, s51, 2
    s_and_b32 s73, s73, 3
    s_mul_i32 s73, s73, 12288
    s_add_u32 s73, s73, s83
    buffer_load_dwordx4 v[128:131], v9, s[28:31], s73 offen sc1
    s_waitcnt vmcnt(22)
    v_mfma_f32_16x16x32_bf16 v[36:39], a[40:43], v[132:135], v[36:39]
    v_mfma_f32_16x16x32_bf16 v[40:43], a[44:47], v[132:135], v[40:43]
    v_mfma_f32_16x16x32_bf16 v[44:47], a[48:51], v[132:135], v[44:47]
    v_mfma_f32_16x16x32_bf16 v[48:51], a[52:55], v[132:135], v[48:51]
    v_mfma_f32_16x16x32_bf16 v[52:55], a[56:59], v[132:135], v[52:55]
    buffer_load_dwordx4 a[232:235], v2, s[28:31], s75 offen offset:3072 sc1
    buffer_load_dwordx4 v[132:135], v10, s[28:31], s73 offen sc1
    s_waitcnt vmcnt(23)
    v_mfma_f32_16x16x32_bf16 v[56:59], a[40:43], v[136:139], v[56:59]
    v_mfma_f32_16x16x32_bf16 v[60:63], a[44:47], v[136:139], v[60:63]
    v_mfma_f32_16x16x32_bf16 v[64:67], a[48:51], v[136:139], v[64:67]
    v_mfma_f32_16x16x32_bf16 v[68:71], a[52:55], v[136:139], v[68:71]
    v_mfma_f32_16x16x32_bf16 v[72:75], a[56:59], v[136:139], v[72:75]
    buffer_load_dwordx4 a[236:239], v0, s[28:31], s75 offen offset:0 sc1
    s_waitcnt vmcnt(13)
    s_lshl_b32 s63, s2, 7
    s_lshl_b32 s62, s3, 3
    s_add_u32 s63, s63, s62
    s_add_u32 s63, s63, 200704
    buffer_store_dwordx2 v[4:5], v3, s[28:31], s63 offen sc1
    buffer_load_dwordx4 v[136:139], v11, s[28:31], s73 offen sc1
    v_mfma_f32_16x16x32_bf16 v[76:79], a[40:43], v[140:143], v[76:79]
    v_mfma_f32_16x16x32_bf16 v[80:83], a[44:47], v[140:143], v[80:83]
    v_mfma_f32_16x16x32_bf16 v[84:87], a[48:51], v[140:143], v[84:87]
    v_mfma_f32_16x16x32_bf16 v[88:91], a[52:55], v[140:143], v[88:91]
    v_mfma_f32_16x16x32_bf16 v[92:95], a[56:59], v[140:143], v[92:95]
    s_add_u32 s75, s82, 0
    buffer_load_dwordx4 a[240:243], v2, s[28:31], s75 offen offset:0 sc1
    buffer_load_dwordx4 v[140:143], v12, s[28:31], s73 offen sc1
    v_mfma_f32_16x16x32_bf16 v[16:19], a[60:63], v[144:147], v[16:19]
    v_mfma_f32_16x16x32_bf16 v[20:23], a[64:67], v[144:147], v[20:23]
    v_mfma_f32_16x16x32_bf16 v[24:27], a[68:71], v[144:147], v[24:27]
    v_mfma_f32_16x16x32_bf16 v[28:31], a[72:75], v[144:147], v[28:31]
    v_mfma_f32_16x16x32_bf16 v[32:35], a[76:79], v[144:147], v[32:35]
    buffer_load_dwordx4 a[244:247], v2, s[28:31], s75 offen offset:1024 sc1
    s_add_u32 s73, s73, 4096
    buffer_load_dwordx4 v[144:147], v9, s[28:31], s73 offen sc1
    v_mfma_f32_16x16x32_bf16 v[36:39], a[60:63], v[148:151], v[36:39]
    v_mfma_f32_16x16x32_bf16 v[40:43], a[64:67], v[148:151], v[40:43]
    v_mfma_f32_16x16x32_bf16 v[44:47], a[68:71], v[148:151], v[44:47]
    v_mfma_f32_16x16x32_bf16 v[48:51], a[72:75], v[148:151], v[48:51]
    v_mfma_f32_16x16x32_bf16 v[52:55], a[76:79], v[148:151], v[52:55]
    buffer_load_dwordx4 a[248:251], v2, s[28:31], s75 offen offset:2048 sc1
    buffer_load_dwordx4 v[148:151], v10, s[28:31], s73 offen sc1
    v_mfma_f32_16x16x32_bf16 v[56:59], a[60:63], v[152:155], v[56:59]
    v_mfma_f32_16x16x32_bf16 v[60:63], a[64:67], v[152:155], v[60:63]
    v_mfma_f32_16x16x32_bf16 v[64:67], a[68:71], v[152:155], v[64:67]
    v_mfma_f32_16x16x32_bf16 v[68:71], a[72:75], v[152:155], v[68:71]
    v_mfma_f32_16x16x32_bf16 v[72:75], a[76:79], v[152:155], v[72:75]
    buffer_load_dwordx4 a[252:255], v2, s[28:31], s75 offen offset:3072 sc1
    buffer_load_dwordx4 v[152:155], v11, s[28:31], s73 offen sc1
    v_mfma_f32_16x16x32_bf16 v[76:79], a[60:63], v[156:159], v[76:79]
    v_mfma_f32_16x16x32_bf16 v[80:83], a[64:67], v[156:159], v[80:83]
    v_mfma_f32_16x16x32_bf16 v[84:87], a[68:71], v[156:159], v[84:87]
    v_mfma_f32_16x16x32_bf16 v[88:91], a[72:75], v[156:159], v[88:91]
    v_mfma_f32_16x16x32_bf16 v[92:95], a[76:79], v[156:159], v[92:95]
    buffer_load_dwordx4 v[172:175], v0, s[28:31], s75 offen offset:0 sc1
    buffer_load_dwordx4 v[156:159], v12, s[28:31], s73 offen sc1
    v_mfma_f32_16x16x32_bf16 v[16:19], a[80:83], v[96:99], v[16:19]
    v_mfma_f32_16x16x32_bf16 v[20:23], a[84:87], v[96:99], v[20:23]
    v_mfma_f32_16x16x32_bf16 v[24:27], a[88:91], v[96:99], v[24:27]
    v_mfma_f32_16x16x32_bf16 v[28:31], a[92:95], v[96:99], v[28:31]
    v_mfma_f32_16x16x32_bf16 v[32:35], a[96:99], v[96:99], v[32:35]
    s_add_u32 s75, s82, 5120
    buffer_load_dwordx4 v[176:179], v2, s[28:31], s75 offen offset:0 sc1
    s_add_u32 s73, s73, 4096
    buffer_load_dwordx4 v[96:99], v9, s[28:31], s73 offen sc1
    v_mfma_f32_16x16x32_bf16 v[36:39], a[80:83], v[100:103], v[36:39]
    v_mfma_f32_16x16x32_bf16 v[40:43], a[84:87], v[100:103], v[40:43]
    v_mfma_f32_16x16x32_bf16 v[44:47], a[88:91], v[100:103], v[44:47]
    v_mfma_f32_16x16x32_bf16 v[48:51], a[92:95], v[100:103], v[48:51]
    v_mfma_f32_16x16x32_bf16 v[52:55], a[96:99], v[100:103], v[52:55]
    buffer_load_dwordx4 v[180:183], v2, s[28:31], s75 offen offset:1024 sc1
    buffer_load_dwordx4 v[100:103], v10, s[28:31], s73 offen sc1
    v_mfma_f32_16x16x32_bf16 v[56:59], a[80:83], v[104:107], v[56:59]
    v_mfma_f32_16x16x32_bf16 v[60:63], a[84:87], v[104:107], v[60:63]
    v_mfma_f32_16x16x32_bf16 v[64:67], a[88:91], v[104:107], v[64:67]
    v_mfma_f32_16x16x32_bf16 v[68:71], a[92:95], v[104:107], v[68:71]
    v_mfma_f32_16x16x32_bf16 v[72:75], a[96:99], v[104:107], v[72:75]
    buffer_load_dwordx4 v[184:187], v2, s[28:31], s75 offen offset:2048 sc1
    buffer_load_dwordx4 v[104:107], v11, s[28:31], s73 offen sc1
    s_waitcnt vmcnt(30)
    v_mfma_f32_16x16x32_bf16 v[76:79], a[80:83], v[108:111], v[76:79]
    v_mfma_f32_16x16x32_bf16 v[80:83], a[84:87], v[108:111], v[80:83]
    v_mfma_f32_16x16x32_bf16 v[84:87], a[88:91], v[108:111], v[84:87]
    v_mfma_f32_16x16x32_bf16 v[88:91], a[92:95], v[108:111], v[88:91]
    v_mfma_f32_16x16x32_bf16 v[92:95], a[96:99], v[108:111], v[92:95]
    buffer_load_dwordx4 v[188:191], v2, s[28:31], s75 offen offset:3072 sc1
    buffer_load_dwordx4 v[108:111], v12, s[28:31], s73 offen sc1
    s_waitcnt vmcnt(31)
    v_mfma_f32_16x16x32_bf16 v[16:19], a[100:103], v[112:115], v[16:19]
    v_mfma_f32_16x16x32_bf16 v[20:23], a[104:107], v[112:115], v[20:23]
    v_mfma_f32_16x16x32_bf16 v[24:27], a[108:111], v[112:115], v[24:27]
    v_mfma_f32_16x16x32_bf16 v[28:31], a[112:115], v[112:115], v[28:31]
    v_mfma_f32_16x16x32_bf16 v[32:35], a[116:119], v[112:115], v[32:35]
    buffer_load_dwordx4 v[192:195], v0, s[28:31], s75 offen offset:0 sc1
    s_add_u32 s73, s51, 3
    s_and_b32 s73, s73, 3
    s_mul_i32 s73, s73, 12288
    s_add_u32 s73, s73, s83
    buffer_load_dwordx4 v[112:115], v9, s[28:31], s73 offen sc1
    s_waitcnt vmcnt(31)
    v_mfma_f32_16x16x32_bf16 v[36:39], a[100:103], v[116:119], v[36:39]
    v_mfma_f32_16x16x32_bf16 v[40:43], a[104:107], v[116:119], v[40:43]
    v_mfma_f32_16x16x32_bf16 v[44:47], a[108:111], v[116:119], v[44:47]
    v_mfma_f32_16x16x32_bf16 v[48:51], a[112:115], v[116:119], v[48:51]
    v_mfma_f32_16x16x32_bf16 v[52:55], a[116:119], v[116:119], v[52:55]
    s_add_u32 s75, s82, 10240
    buffer_load_dwordx4 v[196:199], v2, s[28:31], s75 offen offset:0 sc1
    buffer_load_dwordx4 v[116:119], v10, s[28:31], s73 offen sc1
    s_waitcnt vmcnt(31)
    v_mfma_f32_16x16x32_bf16 v[56:59], a[100:103], v[120:123], v[56:59]
    v_mfma_f32_16x16x32_bf16 v[60:63], a[104:107], v[120:123], v[60:63]
    v_mfma_f32_16x16x32_bf16 v[64:67], a[108:111], v[120:123], v[64:67]
    v_mfma_f32_16x16x32_bf16 v[68:71], a[112:115], v[120:123], v[68:71]
    v_mfma_f32_16x16x32_bf16 v[72:75], a[116:119], v[120:123], v[72:75]
    buffer_load_dwordx4 v[200:203], v2, s[28:31], s75 offen offset:1024 sc1
    buffer_load_dwordx4 v[120:123], v11, s[28:31], s73 offen sc1
    s_waitcnt vmcnt(31)
    v_mfma_f32_16x16x32_bf16 v[76:79], a[100:103], v[124:127], v[76:79]
    v_mfma_f32_16x16x32_bf16 v[80:83], a[104:107], v[124:127], v[80:83]
    v_mfma_f32_16x16x32_bf16 v[84:87], a[108:111], v[124:127], v[84:87]
    v_mfma_f32_16x16x32_bf16 v[88:91], a[112:115], v[124:127], v[88:91]
    v_mfma_f32_16x16x32_bf16 v[92:95], a[116:119], v[124:127], v[92:95]
    buffer_load_dwordx4 v[204:207], v2, s[28:31], s75 offen offset:2048 sc1
    buffer_load_dwordx4 v[124:127], v12, s[28:31], s73 offen sc1
    s_waitcnt vmcnt(31)
    v_mfma_f32_16x16x32_bf16 v[16:19], a[120:123], v[128:131], v[16:19]
    v_mfma_f32_16x16x32_bf16 v[20:23], a[124:127], v[128:131], v[20:23]
    v_mfma_f32_16x16x32_bf16 v[24:27], a[128:131], v[128:131], v[24:27]
    v_mfma_f32_16x16x32_bf16 v[28:31], a[132:135], v[128:131], v[28:31]
    v_mfma_f32_16x16x32_bf16 v[32:35], a[136:139], v[128:131], v[32:35]
    buffer_load_dwordx4 v[208:211], v2, s[28:31], s75 offen offset:3072 sc1
    s_add_u32 s73, s73, 4096
    buffer_load_dwordx4 v[128:131], v9, s[28:31], s73 offen sc1
    s_waitcnt vmcnt(31)
    v_mfma_f32_16x16x32_bf16 v[36:39], a[120:123], v[132:135], v[36:39]
    v_mfma_f32_16x16x32_bf16 v[40:43], a[124:127], v[132:135], v[40:43]
    v_mfma_f32_16x16x32_bf16 v[44:47], a[128:131], v[132:135], v[44:47]
    v_mfma_f32_16x16x32_bf16 v[48:51], a[132:135], v[132:135], v[48:51]
    v_mfma_f32_16x16x32_bf16 v[52:55], a[136:139], v[132:135], v[52:55]
    buffer_load_dwordx4 v[212:215], v0, s[28:31], s75 offen offset:0 sc1
    buffer_load_dwordx4 v[132:135], v10, s[28:31], s73 offen sc1
    s_waitcnt vmcnt(30)
    v_mfma_f32_16x16x32_bf16 v[56:59], a[120:123], v[136:139], v[56:59]
    v_mfma_f32_16x16x32_bf16 v[60:63], a[124:127], v[136:139], v[60:63]
    v_mfma_f32_16x16x32_bf16 v[64:67], a[128:131], v[136:139], v[64:67]
    v_mfma_f32_16x16x32_bf16 v[68:71], a[132:135], v[136:139], v[68:71]
    v_mfma_f32_16x16x32_bf16 v[72:75], a[136:139], v[136:139], v[72:75]
    s_add_u32 s75, s82, 15360
    buffer_load_dwordx4 v[216:219], v2, s[28:31], s75 offen offset:0 sc1
    buffer_load_dwordx4 v[136:139], v11, s[28:31], s73 offen sc1
    s_waitcnt vmcnt(30)
    v_mfma_f32_16x16x32_bf16 v[76:79], a[120:123], v[140:143], v[76:79]
    v_mfma_f32_16x16x32_bf16 v[80:83], a[124:127], v[140:143], v[80:83]
    v_mfma_f32_16x16x32_bf16 v[84:87], a[128:131], v[140:143], v[84:87]
    v_mfma_f32_16x16x32_bf16 v[88:91], a[132:135], v[140:143], v[88:91]
    v_mfma_f32_16x16x32_bf16 v[92:95], a[136:139], v[140:143], v[92:95]
    buffer_load_dwordx4 v[220:223], v2, s[28:31], s75 offen offset:1024 sc1
    buffer_load_dwordx4 v[140:143], v12, s[28:31], s73 offen sc1
    s_waitcnt vmcnt(30)
    v_mfma_f32_16x16x32_bf16 v[16:19], a[140:143], v[144:147], v[16:19]
    v_mfma_f32_16x16x32_bf16 v[20:23], a[144:147], v[144:147], v[20:23]
    v_mfma_f32_16x16x32_bf16 v[24:27], a[148:151], v[144:147], v[24:27]
    v_mfma_f32_16x16x32_bf16 v[28:31], a[152:155], v[144:147], v[28:31]
    v_mfma_f32_16x16x32_bf16 v[32:35], a[156:159], v[144:147], v[32:35]
    buffer_load_dwordx4 v[224:227], v2, s[28:31], s75 offen offset:2048 sc1
    s_add_u32 s73, s73, 4096
    buffer_load_dwordx4 v[144:147], v9, s[28:31], s73 offen sc1
    s_waitcnt vmcnt(30)
    v_mfma_f32_16x16x32_bf16 v[36:39], a[140:143], v[148:151], v[36:39]
    v_mfma_f32_16x16x32_bf16 v[40:43], a[144:147], v[148:151], v[40:43]
    v_mfma_f32_16x16x32_bf16 v[44:47], a[148:151], v[148:151], v[44:47]
    v_mfma_f32_16x16x32_bf16 v[48:51], a[152:155], v[148:151], v[48:51]
    v_mfma_f32_16x16x32_bf16 v[52:55], a[156:159], v[148:151], v[52:55]
    buffer_load_dwordx4 v[228:231], v2, s[28:31], s75 offen offset:3072 sc1
    buffer_load_dwordx4 v[148:151], v10, s[28:31], s73 offen sc1
    s_waitcnt vmcnt(30)
    v_mfma_f32_16x16x32_bf16 v[56:59], a[140:143], v[152:155], v[56:59]
    v_mfma_f32_16x16x32_bf16 v[60:63], a[144:147], v[152:155], v[60:63]
    v_mfma_f32_16x16x32_bf16 v[64:67], a[148:151], v[152:155], v[64:67]
    v_mfma_f32_16x16x32_bf16 v[68:71], a[152:155], v[152:155], v[68:71]
    v_mfma_f32_16x16x32_bf16 v[72:75], a[156:159], v[152:155], v[72:75]
    buffer_load_dwordx4 v[232:235], v0, s[28:31], s75 offen offset:0 sc1
    v_and_b32 v13, 3, v1
    v_lshlrev_b32 v13, 10, v13
    v_bfe_u32 v15, v1, 2, 1
    v_lshl_add_u32 v14, v15, 3, v13
    s_lshr_b32 s52, s48, 1
    s_and_b32 s53, s52, 7
    s_lshl_b32 s53, s53, 5
    s_lshr_b32 s52, s52, 3
    s_lshl_b32 s52, s52, 2
    s_add_u32 s52, s52, s53
    s_add_u32 s53, s3, 0
    s_and_b32 s53, s53, 3
    s_add_u32 s52, s52, s53
    s_lshl_b32 s52, s52, 7
    s_and_b32 s53, s48, 1
    s_lshl_b32 s53, s53, 4
    s_add_u32 s52, s52, s53
    s_add_u32 s65, s52, 200704
    buffer_load_dwordx2 v[170:171], v14, s[28:31], s65 offen sc1
    buffer_load_dwordx4 v[152:155], v11, s[28:31], s73 offen sc1
    s_waitcnt vmcnt(31)
    v_mfma_f32_16x16x32_bf16 v[76:79], a[140:143], v[156:159], v[76:79]
    v_mfma_f32_16x16x32_bf16 v[80:83], a[144:147], v[156:159], v[80:83]
    v_mfma_f32_16x16x32_bf16 v[84:87], a[148:151], v[156:159], v[84:87]
    v_mfma_f32_16x16x32_bf16 v[88:91], a[152:155], v[156:159], v[88:91]
    v_mfma_f32_16x16x32_bf16 v[92:95], a[156:159], v[156:159], v[92:95]
    s_add_u32 s75, s82, 20480
    buffer_load_dwordx4 v[236:239], v2, s[28:31], s75 offen offset:0 sc1
    buffer_load_dwordx4 v[156:159], v12, s[28:31], s73 offen sc1
    s_waitcnt vmcnt(31)
    v_mfma_f32_16x16x32_bf16 v[16:19], a[160:163], v[96:99], v[16:19]
    v_mfma_f32_16x16x32_bf16 v[20:23], a[164:167], v[96:99], v[20:23]
    v_mfma_f32_16x16x32_bf16 v[24:27], a[168:171], v[96:99], v[24:27]
    v_mfma_f32_16x16x32_bf16 v[28:31], a[172:175], v[96:99], v[28:31]
    v_mfma_f32_16x16x32_bf16 v[32:35], a[176:179], v[96:99], v[32:35]
    buffer_load_dwordx4 v[240:243], v2, s[28:31], s75 offen offset:1024 sc1
    s_waitcnt vmcnt(30)
    v_mfma_f32_16x16x32_bf16 v[36:39], a[160:163], v[100:103], v[36:39]
    v_mfma_f32_16x16x32_bf16 v[40:43], a[164:167], v[100:103], v[40:43]
    v_mfma_f32_16x16x32_bf16 v[44:47], a[168:171], v[100:103], v[44:47]
    v_mfma_f32_16x16x32_bf16 v[48:51], a[172:175], v[100:103], v[48:51]
    v_mfma_f32_16x16x32_bf16 v[52:55], a[176:179], v[100:103], v[52:55]
    buffer_load_dwordx4 v[244:247], v2, s[28:31], s75 offen offset:2048 sc1
    s_waitcnt vmcnt(29)
    v_mfma_f32_16x16x32_bf16 v[56:59], a[160:163], v[104:107], v[56:59]
    v_mfma_f32_16x16x32_bf16 v[60:63], a[164:167], v[104:107], v[60:63]
    v_mfma_f32_16x16x32_bf16 v[64:67], a[168:171], v[104:107], v[64:67]
    v_mfma_f32_16x16x32_bf16 v[68:71], a[172:175], v[104:107], v[68:71]
    v_mfma_f32_16x16x32_bf16 v[72:75], a[176:179], v[104:107], v[72:75]
    buffer_load_dwordx4 v[248:251], v2, s[28:31], s75 offen offset:3072 sc1
    s_waitcnt vmcnt(28)
    v_mfma_f32_16x16x32_bf16 v[76:79], a[160:163], v[108:111], v[76:79]
    v_mfma_f32_16x16x32_bf16 v[80:83], a[164:167], v[108:111], v[80:83]
    v_mfma_f32_16x16x32_bf16 v[84:87], a[168:171], v[108:111], v[84:87]
    v_mfma_f32_16x16x32_bf16 v[88:91], a[172:175], v[108:111], v[88:91]
    v_mfma_f32_16x16x32_bf16 v[92:95], a[176:179], v[108:111], v[92:95]
    buffer_load_dwordx4 v[252:255], v0, s[28:31], s75 offen offset:0 sc1
    s_waitcnt vmcnt(27)
    v_mfma_f32_16x16x32_bf16 v[16:19], a[180:183], v[112:115], v[16:19]
    v_mfma_f32_16x16x32_bf16 v[20:23], a[184:187], v[112:115], v[20:23]
    v_mfma_f32_16x16x32_bf16 v[24:27], a[188:191], v[112:115], v[24:27]
    v_mfma_f32_16x16x32_bf16 v[28:31], a[192:195], v[112:115], v[28:31]
    v_mfma_f32_16x16x32_bf16 v[32:35], a[196:199], v[112:115], v[32:35]
    s_waitcnt vmcnt(25)
    v_mfma_f32_16x16x32_bf16 v[36:39], a[180:183], v[116:119], v[36:39]
    v_mfma_f32_16x16x32_bf16 v[40:43], a[184:187], v[116:119], v[40:43]
    v_mfma_f32_16x16x32_bf16 v[44:47], a[188:191], v[116:119], v[44:47]
    v_mfma_f32_16x16x32_bf16 v[48:51], a[192:195], v[116:119], v[48:51]
    v_mfma_f32_16x16x32_bf16 v[52:55], a[196:199], v[116:119], v[52:55]
    s_waitcnt vmcnt(23)
    v_mfma_f32_16x16x32_bf16 v[56:59], a[180:183], v[120:123], v[56:59]
    v_mfma_f32_16x16x32_bf16 v[60:63], a[184:187], v[120:123], v[60:63]
    v_mfma_f32_16x16x32_bf16 v[64:67], a[188:191], v[120:123], v[64:67]
    v_mfma_f32_16x16x32_bf16 v[68:71], a[192:195], v[120:123], v[68:71]
    v_mfma_f32_16x16x32_bf16 v[72:75], a[196:199], v[120:123], v[72:75]
    s_waitcnt vmcnt(7)
    v_cmp_ne_u64 vcc, s[44:45], v[170:171]
    s_nop 0
    s_cbranch_vccnz L_slow_28
L_back_29:
    s_add_u32 s73, s84, 0
    buffer_load_dwordx4 v[96:99], v9, s[28:31], s73 offen sc1
    buffer_load_dwordx4 v[100:103], v10, s[28:31], s73 offen sc1
    buffer_load_dwordx4 v[104:107], v11, s[28:31], s73 offen sc1
    buffer_load_dwordx4 v[108:111], v12, s[28:31], s73 offen sc1
    s_add_u32 s73, s84, 4096
    buffer_load_dwordx4 v[112:115], v9, s[28:31], s73 offen sc1
    buffer_load_dwordx4 v[116:119], v10, s[28:31], s73 offen sc1
    buffer_load_dwordx4 v[120:123], v11, s[28:31], s73 offen sc1
    v_mfma_f32_16x16x32_bf16 v[76:79], a[180:183], v[124:127], v[76:79]
    v_mfma_f32_16x16x32_bf16 v[80:83], a[184:187], v[124:127], v[80:83]
    v_mfma_f32_16x16x32_bf16 v[84:87], a[188:191], v[124:127], v[84:87]
    v_mfma_f32_16x16x32_bf16 v[88:91], a[192:195], v[124:127], v[88:91]
    v_mfma_f32_16x16x32_bf16 v[92:95], a[196:199], v[124:127], v[92:95]
    buffer_load_dwordx4 v[124:127], v12, s[28:31], s73 offen sc1
    v_mfma_f32_16x16x32_bf16 v[16:19], a[200:203], v[128:131], v[16:19]
    v_mfma_f32_16x16x32_bf16 v[20:23], a[204:207], v[128:131], v[20:23]
    v_mfma_f32_16x16x32_bf16 v[24:27], a[208:211], v[128:131], v[24:27]
    v_mfma_f32_16x16x32_bf16 v[28:31], a[212:215], v[128:131], v[28:31]
    v_mfma_f32_16x16x32_bf16 v[32:35], a[216:219], v[128:131], v[32:35]
    s_add_u32 s73, s84, 8192
    buffer_load_dwordx4 v[128:131], v9, s[28:31], s73 offen sc1
    v_mfma_f32_16x16x32_bf16 v[36:39], a[200:203], v[132:135], v[36:39]
    v_mfma_f32_16x16x32_bf16 v[40:43], a[204:207], v[132:135], v[40:43]
    v_mfma_f32_16x16x32_bf16 v[44:47], a[208:211], v[132:135], v[44:47]
    v_mfma_f32_16x16x32_bf16 v[48:51], a[212:215], v[132:135], v[48:51]
    v_mfma_f32_16x16x32_bf16 v[52:55], a[216:219], v[132:135], v[52:55]
    buffer_load_dwordx4 v[132:135], v10, s[28:31], s73 offen sc1
    v_mfma_f32_16x16x32_bf16 v[56:59], a[200:203], v[136:139], v[56:59]
    v_mfma_f32_16x16x32_bf16 v[60:63], a[204:207], v[136:139], v[60:63]
    v_mfma_f32_16x16x32_bf16 v[64:67], a[208:211], v[136:139], v[64:67]
    v_mfma_f32_16x16x32_bf16 v[68:71], a[212:215], v[136:139], v[68:71]
    v_mfma_f32_16x16x32_bf16 v[72:75], a[216:219], v[136:139], v[72:75]
    buffer_load_dwordx4 v[136:139], v11, s[28:31], s73 offen sc1
    v_mfma_f32_16x16x32_bf16 v[76:79], a[200:203], v[140:143], v[76:79]
    v_mfma_f32_16x16x32_bf16 v[80:83], a[204:207], v[140:143], v[80:83]
    v_mfma_f32_16x16x32_bf16 v[84:87], a[208:211], v[140:143], v[84:87]
    v_mfma_f32_16x16x32_bf16 v[88:91], a[212:215], v[140:143], v[88:91]
    v_mfma_f32_16x16x32_bf16 v[92:95], a[216:219], v[140:143], v[92:95]
    buffer_load_dwordx4 v[140:143], v12, s[28:31], s73 offen sc1
    v_mfma_f32_16x16x32_bf16 v[16:19], a[220:223], v[144:147], v[16:19]
    v_mfma_f32_16x16x32_bf16 v[20:23], a[224:227], v[144:147], v[20:23]
    v_mfma_f32_16x16x32_bf16 v[24:27], a[228:231], v[144:147], v[24:27]
    v_mfma_f32_16x16x32_bf16 v[28:31], a[232:235], v[144:147], v[28:31]
    v_mfma_f32_16x16x32_bf16 v[32:35], a[236:239], v[144:147], v[32:35]
    s_add_u32 s73, s84, 12288
    buffer_load_dwordx4 v[144:147], v10, s[28:31], s73 offen sc1
    v_mfma_f32_16x16x32_bf16 v[36:39], a[220:223], v[148:151], v[36:39]
    v_mfma_f32_16x16x32_bf16 v[40:43], a[224:227], v[148:151], v[40:43]
    v_mfma_f32_16x16x32_bf16 v[44:47], a[228:231], v[148:151], v[44:47]
    v_mfma_f32_16x16x32_bf16 v[48:51], a[232:235], v[148:151], v[48:51]
    v_mfma_f32_16x16x32_bf16 v[52:55], a[236:239], v[148:151], v[52:55]
    s_add_u32 s73, s84, 16384
    buffer_load_dwordx4 v[148:151], v10, s[28:31], s73 offen sc1
    s_waitcnt vmcnt(20)
    v_mfma_f32_16x16x32_bf16 v[56:59], a[220:223], v[152:155], v[56:59]
    v_mfma_f32_16x16x32_bf16 v[60:63], a[224:227], v[152:155], v[60:63]
    v_mfma_f32_16x16x32_bf16 v[64:67], a[228:231], v[152:155], v[64:67]
    v_mfma_f32_16x16x32_bf16 v[68:71], a[232:235], v[152:155], v[68:71]
    v_mfma_f32_16x16x32_bf16 v[72:75], a[236:239], v[152:155], v[72:75]
    s_add_u32 s73, s84, 12288
    buffer_load_dwordx4 v[152:155], v11, s[28:31], s73 offen sc1
    s_waitcnt vmcnt(19)
    v_mfma_f32_16x16x32_bf16 v[76:79], a[220:223], v[156:159], v[76:79]
    v_mfma_f32_16x16x32_bf16 v[80:83], a[224:227], v[156:159], v[80:83]
    v_mfma_f32_16x16x32_bf16 v[84:87], a[228:231], v[156:159], v[84:87]
    v_mfma_f32_16x16x32_bf16 v[88:91], a[232:235], v[156:159], v[88:91]
    v_mfma_f32_16x16x32_bf16 v[92:95], a[236:239], v[156:159], v[92:95]
    s_add_u32 s73, s84, 16384
    buffer_load_dwordx4 v[156:159], v11, s[28:31], s73 offen sc1
    s_waitcnt vmcnt(15)
    v_mfma_f32_16x16x32_bf16 v[16:19], a[240:243], v[96:99], v[16:19]
    v_mfma_f32_16x16x32_bf16 v[20:23], a[244:247], v[96:99], v[20:23]
    v_mfma_f32_16x16x32_bf16 v[24:27], a[248:251], v[96:99], v[24:27]
    v_mfma_f32_16x16x32_bf16 v[28:31], a[252:255], v[96:99], v[28:31]
    v_mfma_f32_16x16x32_bf16 v[32:35], v[172:175], v[96:99], v[32:35]
    s_add_u32 s73, s84, 12288
    buffer_load_dwordx4 v[96:99], v12, s[28:31], s73 offen sc1
    s_waitcnt vmcnt(15)
    v_mfma_f32_16x16x32_bf16 v[36:39], a[240:243], v[100:103], v[36:39]
    v_mfma_f32_16x16x32_bf16 v[40:43], a[244:247], v[100:103], v[40:43]
    v_mfma_f32_16x16x32_bf16 v[44:47], a[248:251], v[100:103], v[44:47]
    v_mfma_f32_16x16x32_bf16 v[48:51], a[252:255], v[100:103], v[48:51]
    v_mfma_f32_16x16x32_bf16 v[52:55], v[172:175], v[100:103], v[52:55]
    s_add_u32 s73, s84, 16384
    buffer_load_dwordx4 v[100:103], v12, s[28:31], s73 offen sc1
    s_waitcnt vmcnt(15)
    v_mfma_f32_16x16x32_bf16 v[56:59], a[240:243], v[104:107], v[56:59]
    v_mfma_f32_16x16x32_bf16 v[60:63], a[244:247], v[104:107], v[60:63]
    v_mfma_f32_16x16x32_bf16 v[64:67], a[248:251], v[104:107], v[64:67]
    v_mfma_f32_16x16x32_bf16 v[68:71], a[252:255], v[104:107], v[68:71]
    v_mfma_f32_16x16x32_bf16 v[72:75], v[172:175], v[104:107], v[72:75]
    buffer_load_dwordx2 v[160:161], v7, s[4:7], s85 offen offset:0
    buffer_load_dwordx2 v[162:163], v7, s[4:7], s85 offen offset:32
    buffer_load_dwordx2 v[164:165], v7, s[4:7], s85 offen offset:64
    buffer_load_dwordx2 v[166:167], v7, s[4:7], s85 offen offset:96
    buffer_load_dwordx2 v[168:169], v7, s[4:7], s85 offen offset:128
    s_add_u32 s73, s84, 12288
    buffer_load_dwordx4 v[104:107], v9, s[28:31], s73 offen sc1
    s_waitcnt vmcnt(20)
    v_mfma_f32_16x16x32_bf16 v[76:79], a[240:243], v[108:111], v[76:79]
    v_mfma_f32_16x16x32_bf16 v[80:83], a[244:247], v[108:111], v[80:83]
    v_mfma_f32_16x16x32_bf16 v[84:87], a[248:251], v[108:111], v[84:87]
    v_mfma_f32_16x16x32_bf16 v[88:91], a[252:255], v[108:111], v[88:91]
    v_mfma_f32_16x16x32_bf16 v[92:95], v[172:175], v[108:111], v[92:95]
    s_add_u32 s73, s84, 16384
    buffer_load_dwordx4 v[108:111], v9, s[28:31], s73 offen sc1
    s_waitcnt vmcnt(20)
    v_mfma_f32_16x16x32_bf16 v[16:19], v[176:179], v[112:115], v[16:19]
    v_mfma_f32_16x16x32_bf16 v[20:23], v[180:183], v[112:115], v[20:23]
    v_mfma_f32_16x16x32_bf16 v[24:27], v[184:187], v[112:115], v[24:27]
    v_mfma_f32_16x16x32_bf16 v[28:31], v[188:191], v[112:115], v[28:31]
    v_mfma_f32_16x16x32_bf16 v[32:35], v[192:195], v[112:115], v[32:35]
    s_waitcnt vmcnt(19)
    v_mfma_f32_16x16x32_bf16 v[36:39], v[176:179], v[116:119], v[36:39]
    v_mfma_f32_16x16x32_bf16 v[40:43], v[180:183], v[116:119], v[40:43]
    v_mfma_f32_16x16x32_bf16 v[44:47], v[184:187], v[116:119], v[44:47]
    v_mfma_f32_16x16x32_bf16 v[48:51], v[188:191], v[116:119], v[48:51]
    v_mfma_f32_16x16x32_bf16 v[52:55], v[192:195], v[116:119], v[52:55]
    s_waitcnt vmcnt(18)
    v_mfma_f32_16x16x32_bf16 v[56:59], v[176:179], v[120:123], v[56:59]
    v_mfma_f32_16x16x32_bf16 v[60:63], v[180:183], v[120:123], v[60:63]
    v_mfma_f32_16x16x32_bf16 v[64:67], v[184:187], v[120:123], v[64:67]
    v_mfma_f32_16x16x32_bf16 v[68:71], v[188:191], v[120:123], v[68:71]
    v_mfma_f32_16x16x32_bf16 v[72:75], v[192:195], v[120:123], v[72:75]
    s_waitcnt vmcnt(17)
    v_mfma_f32_16x16x32_bf16 v[76:79], v[176:179], v[124:127], v[76:79]
    v_mfma_f32_16x16x32_bf16 v[80:83], v[180:183], v[124:127], v[80:83]
    v_mfma_f32_16x16x32_bf16 v[84:87], v[184:187], v[124:127], v[84:87]
    v_mfma_f32_16x16x32_bf16 v[88:91], v[188:191], v[124:127], v[88:91]
    v_mfma_f32_16x16x32_bf16 v[92:95], v[192:195], v[124:127], v[92:95]
    s_waitcnt vmcnt(16)
    v_mfma_f32_16x16x32_bf16 v[16:19], v[196:199], v[128:131], v[16:19]
    v_mfma_f32_16x16x32_bf16 v[20:23], v[200:203], v[128:131], v[20:23]
    v_mfma_f32_16x16x32_bf16 v[24:27], v[204:207], v[128:131], v[24:27]
    v_mfma_f32_16x16x32_bf16 v[28:31], v[208:211], v[128:131], v[28:31]
    v_mfma_f32_16x16x32_bf16 v[32:35], v[212:215], v[128:131], v[32:35]
    s_waitcnt vmcnt(15)
    v_mfma_f32_16x16x32_bf16 v[36:39], v[196:199], v[132:135], v[36:39]
    v_mfma_f32_16x16x32_bf16 v[40:43], v[200:203], v[132:135], v[40:43]
    v_mfma_f32_16x16x32_bf16 v[44:47], v[204:207], v[132:135], v[44:47]
    v_mfma_f32_16x16x32_bf16 v[48:51], v[208:211], v[132:135], v[48:51]
    v_mfma_f32_16x16x32_bf16 v[52:55], v[212:215], v[132:135], v[52:55]
    s_waitcnt vmcnt(14)
    v_mfma_f32_16x16x32_bf16 v[56:59], v[196:199], v[136:139], v[56:59]
    v_mfma_f32_16x16x32_bf16 v[60:63], v[200:203], v[136:139], v[60:63]
    v_mfma_f32_16x16x32_bf16 v[64:67], v[204:207], v[136:139], v[64:67]
    v_mfma_f32_16x16x32_bf16 v[68:71], v[208:211], v[136:139], v[68:71]
    v_mfma_f32_16x16x32_bf16 v[72:75], v[212:215], v[136:139], v[72:75]
    s_waitcnt vmcnt(13)
    v_mfma_f32_16x16x32_bf16 v[76:79], v[196:199], v[140:143], v[76:79]
    v_mfma_f32_16x16x32_bf16 v[80:83], v[200:203], v[140:143], v[80:83]
    v_mfma_f32_16x16x32_bf16 v[84:87], v[204:207], v[140:143], v[84:87]
    v_mfma_f32_16x16x32_bf16 v[88:91], v[208:211], v[140:143], v[88:91]
    v_mfma_f32_16x16x32_bf16 v[92:95], v[212:215], v[140:143], v[92:95]
    s_waitcnt vmcnt(12)
    v_mfma_f32_16x16x32_bf16 v[36:39], v[216:219], v[144:147], v[36:39]
    s_branch L_padskip5
.p2align 12
L_pad5:
    s_setpc_b64 s[62:63]
L_padskip5:
    v_mfma_f32_16x16x32_bf16 v[40:43], v[220:223], v[144:147], v[40:43]
    v_mfma_f32_16x16x32_bf16 v[44:47], v[224:227], v[144:147], v[44:47]
    v_mfma_f32_16x16x32_bf16 v[48:51], v[228:231], v[144:147], v[48:51]
    v_mfma_f32_16x16x32_bf16 v[52:55], v[232:235], v[144:147], v[52:55]
    s_waitcnt vmcnt(11)
    v_mfma_f32_16x16x32_bf16 v[36:39], v[236:239], v[148:151], v[36:39]
    v_mfma_f32_16x16x32_bf16 v[40:43], v[240:243], v[148:151], v[40:43]
    v_mfma_f32_16x16x32_bf16 v[44:47], v[244:247], v[148:151], v[44:47]
    v_mfma_f32_16x16x32_bf16 v[48:51], v[248:251], v[148:151], v[48:51]
    v_mfma_f32_16x16x32_bf16 v[52:55], v[252:255], v[148:151], v[52:55]
    s_waitcnt vmcnt(10)
    v_mfma_f32_16x16x32_bf16 v[56:59], v[216:219], v[152:155], v[56:59]
    v_mfma_f32_16x16x32_bf16 v[60:63], v[220:223], v[152:155], v[60:63]
    v_mfma_f32_16x16x32_bf16 v[64:67], v[224:227], v[152:155], v[64:67]
    v_mfma_f32_16x16x32_bf16 v[68:71], v[228:231], v[152:155], v[68:71]
    v_mfma_f32_16x16x32_bf16 v[72:75], v[232:235], v[152:155], v[72:75]
    s_waitcnt vmcnt(9)
    v_mfma_f32_16x16x32_bf16 v[56:59], v[236:239], v[156:159], v[56:59]
    v_mfma_f32_16x16x32_bf16 v[60:63], v[240:243], v[156:159], v[60:63]
    v_mfma_f32_16x16x32_bf16 v[64:67], v[244:247], v[156:159], v[64:67]
    v_mfma_f32_16x16x32_bf16 v[68:71], v[248:251], v[156:159], v[68:71]
    v_mfma_f32_16x16x32_bf16 v[72:75], v[252:255], v[156:159], v[72:75]
    s_add_u32 s52, s3, 1
    s_and_b32 s52, s52, 3
    s_mul_i32 s52, s52, 15360
    s_add_u32 s52, s52, 0
    v_add_u32 v13, s52, v2
    ds_write_b128 v13, v[36:39] offset:0
    ds_write_b128 v13, v[40:43] offset:1024
    ds_write_b128 v13, v[44:47] offset:2048
    ds_write_b128 v13, v[48:51] offset:3072
    ds_write_b128 v13, v[52:55] offset:4096
    s_waitcnt vmcnt(8)
    v_mfma_f32_16x16x32_bf16 v[76:79], v[216:219], v[96:99], v[76:79]
    v_mfma_f32_16x16x32_bf16 v[80:83], v[220:223], v[96:99], v[80:83]
    v_mfma_f32_16x16x32_bf16 v[84:87], v[224:227], v[96:99], v[84:87]
    v_mfma_f32_16x16x32_bf16 v[88:91], v[228:231], v[96:99], v[88:91]
    v_mfma_f32_16x16x32_bf16 v[92:95], v[232:235], v[96:99], v[92:95]
    s_waitcnt vmcnt(7)
    v_mfma_f32_16x16x32_bf16 v[76:79], v[236:239], v[100:103], v[76:79]
    v_mfma_f32_16x16x32_bf16 v[80:83], v[240:243], v[100:103], v[80:83]
    v_mfma_f32_16x16x32_bf16 v[84:87], v[244:247], v[100:103], v[84:87]
    v_mfma_f32_16x16x32_bf16 v[88:91], v[248:251], v[100:103], v[88:91]
    v_mfma_f32_16x16x32_bf16 v[92:95], v[252:255], v[100:103], v[92:95]
    s_add_u32 s52, s3, 2
    s_and_b32 s52, s52, 3
    s_mul_i32 s52, s52, 15360
    s_add_u32 s52, s52, 5120
    v_add_u32 v15, s52, v2
    ds_write_b128 v15, v[56:59] offset:0
    ds_write_b128 v15, v[60:63] offset:1024
    ds_write_b128 v15, v[64:67] offset:2048
    ds_write_b128 v15, v[68:71] offset:3072
    ds_write_b128 v15, v[72:75] offset:4096
    s_waitcnt vmcnt(1)
    v_mfma_f32_16x16x32_bf16 v[16:19], v[216:219], v[104:107], v[16:19]
    v_mfma_f32_16x16x32_bf16 v[20:23], v[220:223], v[104:107], v[20:23]
    v_mfma_f32_16x16x32_bf16 v[24:27], v[224:227], v[104:107], v[24:27]
    v_mfma_f32_16x16x32_bf16 v[28:31], v[228:231], v[104:107], v[28:31]
    v_mfma_f32_16x16x32_bf16 v[32:35], v[232:235], v[104:107], v[32:35]
    s_waitcnt vmcnt(0)
    v_mfma_f32_16x16x32_bf16 v[16:19], v[236:239], v[108:111], v[16:19]
    v_mfma_f32_16x16x32_bf16 v[20:23], v[240:243], v[108:111], v[20:23]
    v_mfma_f32_16x16x32_bf16 v[24:27], v[244:247], v[108:111], v[24:27]
    v_mfma_f32_16x16x32_bf16 v[28:31], v[248:251], v[108:111], v[28:31]
    v_mfma_f32_16x16x32_bf16 v[32:35], v[252:255], v[108:111], v[32:35]
    s_add_u32 s52, s3, 3
    s_and_b32 s52, s52, 3
    s_mul_i32 s52, s52, 15360
    s_add_u32 s52, s52, 10240
    v_add_u32 v13, s52, v2
    ds_write_b128 v13, v[76:79] offset:0
    ds_write_b128 v13, v[80:83] offset:1024
    ds_write_b128 v13, v[84:87] offset:2048
    ds_write_b128 v13, v[88:91] offset:3072
    ds_write_b128 v13, v[92:95] offset:4096
    s_waitcnt lgkmcnt(0)
    s_barrier
    ds_read_b128 v[96:99], v8 offset:0
    ds_read_b128 v[100:103], v8 offset:1024
    ds_read_b128 v[104:107], v8 offset:2048
    ds_read_b128 v[108:111], v8 offset:3072
    ds_read_b128 v[112:115], v8 offset:4096
    ds_read_b128 v[116:119], v8 offset:5120
    ds_read_b128 v[120:123], v8 offset:6144
    ds_read_b128 v[124:127], v8 offset:7168
    ds_read_b128 v[128:131], v8 offset:8192
    ds_read_b128 v[132:135], v8 offset:9216
    ds_read_b128 v[136:139], v8 offset:10240
    ds_read_b128 v[140:143], v8 offset:11264
    ds_read_b128 v[144:147], v8 offset:12288
    ds_read_b128 v[148:151], v8 offset:13312
    ds_read_b128 v[152:155], v8 offset:14336
    v_lshlrev_b32 v248, 16, v160
    v_and_b32 v249, 0xffff0000, v160
    v_lshlrev_b32 v250, 16, v161
    v_and_b32 v251, 0xffff0000, v161
    v_pk_add_f32 v[16:17], v[16:17], v[248:249]
    v_pk_add_f32 v[18:19], v[18:19], v[250:251]
    v_lshlrev_b32 v248, 16, v162
    v_and_b32 v249, 0xffff0000, v162
    v_lshlrev_b32 v250, 16, v163
    v_and_b32 v251, 0xffff0000, v163
    v_pk_add_f32 v[20:21], v[20:21], v[248:249]
    v_pk_add_f32 v[22:23], v[22:23], v[250:251]
    v_lshlrev_b32 v248, 16, v164
    v_and_b32 v249, 0xffff0000, v164
    v_lshlrev_b32 v250, 16, v165
    v_and_b32 v251, 0xffff0000, v165
    v_pk_add_f32 v[24:25], v[24:25], v[248:249]
    v_pk_add_f32 v[26:27], v[26:27], v[250:251]
    v_lshlrev_b32 v248, 16, v166
    v_and_b32 v249, 0xffff0000, v166
    v_lshlrev_b32 v250, 16, v167
    v_and_b32 v251, 0xffff0000, v167
    v_pk_add_f32 v[28:29], v[28:29], v[248:249]
    v_pk_add_f32 v[30:31], v[30:31], v[250:251]
    v_lshlrev_b32 v248, 16, v168
    v_and_b32 v249, 0xffff0000, v168
    v_lshlrev_b32 v250, 16, v169
    v_and_b32 v251, 0xffff0000, v169
    v_pk_add_f32 v[32:33], v[32:33], v[248:249]
    v_pk_add_f32 v[34:35], v[34:35], v[250:251]
    s_waitcnt lgkmcnt(14)
    v_pk_add_f32 v[16:17], v[16:17], v[96:97]
    v_pk_add_f32 v[18:19], v[18:19], v[98:99]
    s_waitcnt lgkmcnt(9)
    v_pk_add_f32 v[16:17], v[16:17], v[116:117]
    v_pk_add_f32 v[18:19], v[18:19], v[118:119]
    s_waitcnt lgkmcnt(4)
    v_pk_add_f32 v[16:17], v[16:17], v[136:137]
    v_pk_add_f32 v[18:19], v[18:19], v[138:139]
    v_cvt_pk_bf16_f32 v16, v16, v17
    v_cvt_pk_bf16_f32 v17, v18, v19
    buffer_store_dwordx2 v[16:17], v7, s[32:35], s85 offen offset:0
    v_pk_add_f32 v[20:21], v[20:21], v[100:101]
    v_pk_add_f32 v[22:23], v[22:23], v[102:103]
    v_pk_add_f32 v[20:21], v[20:21], v[120:121]
    v_pk_add_f32 v[22:23], v[22:23], v[122:123]
    s_waitcnt lgkmcnt(3)
    v_pk_add_f32 v[20:21], v[20:21], v[140:141]
    v_pk_add_f32 v[22:23], v[22:23], v[142:143]
    v_cvt_pk_bf16_f32 v20, v20, v21
    v_cvt_pk_bf16_f32 v21, v22, v23
    buffer_store_dwordx2 v[20:21], v7, s[32:35], s85 offen offset:32
    v_pk_add_f32 v[24:25], v[24:25], v[104:105]
    v_pk_add_f32 v[26:27], v[26:27], v[106:107]
    v_pk_add_f32 v[24:25], v[24:25], v[124:125]
    v_pk_add_f32 v[26:27], v[26:27], v[126:127]
    s_waitcnt lgkmcnt(2)
    v_pk_add_f32 v[24:25], v[24:25], v[144:145]
    v_pk_add_f32 v[26:27], v[26:27], v[146:147]
    v_cvt_pk_bf16_f32 v24, v24, v25
    v_cvt_pk_bf16_f32 v25, v26, v27
    buffer_store_dwordx2 v[24:25], v7, s[32:35], s85 offen offset:64
    v_pk_add_f32 v[28:29], v[28:29], v[108:109]
    v_pk_add_f32 v[30:31], v[30:31], v[110:111]
    v_pk_add_f32 v[28:29], v[28:29], v[128:129]
    v_pk_add_f32 v[30:31], v[30:31], v[130:131]
    s_waitcnt lgkmcnt(1)
    v_pk_add_f32 v[28:29], v[28:29], v[148:149]
    v_pk_add_f32 v[30:31], v[30:31], v[150:151]
    v_cvt_pk_bf16_f32 v28, v28, v29
    v_cvt_pk_bf16_f32 v29, v30, v31
    buffer_store_dwordx2 v[28:29], v7, s[32:35], s85 offen offset:96
    v_pk_add_f32 v[32:33], v[32:33], v[112:113]
    v_pk_add_f32 v[34:35], v[34:35], v[114:115]
    v_pk_add_f32 v[32:33], v[32:33], v[132:133]
    v_pk_add_f32 v[34:35], v[34:35], v[134:135]
    s_waitcnt lgkmcnt(0)
    v_pk_add_f32 v[32:33], v[32:33], v[152:153]
    v_pk_add_f32 v[34:35], v[34:35], v[154:155]
    v_cvt_pk_bf16_f32 v32, v32, v33
    v_cvt_pk_bf16_f32 v33, v34, v35
    buffer_store_dwordx2 v[32:33], v7, s[32:35], s85 offen offset:128
    s_or_b32 s52, s2, s3
    s_cmp_lg_u32 s52, 0
    s_cbranch_scc1 L_ep_32
    s_mov_b32 s52, 0
    buffer_store_dwordx2 v[4:5], v3, s[28:31], s52 offen sc1
L_ep_32:
    s_waitcnt vmcnt(0)
L_end:
    s_endpgm
L_slow_12:
    s_mov_b32 s64, 0
L_spin_14:
    buffer_load_dwordx2 v[16:17], v14, s[28:31], s65 offen sc1
    s_waitcnt vmcnt(0)
    v_cmp_ne_u64 vcc, s[44:45], v[16:17]
    s_nop 0
    s_cbranch_vccz L_spun_15
    s_add_u32 s64, s64, 1
    s_cmp_lt_u32 s64, 200000
    s_cbranch_scc1 L_spin_14
L_spun_15:
    s_branch L_back_13
L_slow_16:
    s_mov_b32 s64, 0
L_spin_18:
    buffer_load_dwordx2 v[16:17], v14, s[28:31], s65 offen sc1
    s_waitcnt vmcnt(0)
    v_cmp_ne_u64 vcc, s[44:45], v[16:17]
    s_nop 0
    s_cbranch_vccz L_spun_19
    s_add_u32 s64, s64, 1
    s_cmp_lt_u32 s64, 200000
    s_cbranch_scc1 L_spin_18
L_spun_19:
    s_branch L_back_17
L_slow_20:
    s_mov_b32 s64, 0
L_spin_22:
    buffer_load_dwordx2 v[170:171], v14, s[28:31], s65 offen sc1
    s_waitcnt vmcnt(0)
    v_cmp_ne_u64 vcc, s[44:45], v[170:171]
    s_nop 0
    s_cbranch_vccz L_spun_23
    s_add_u32 s64, s64, 1
    s_cmp_lt_u32 s64, 200000
    s_cbranch_scc1 L_spin_22
L_spun_23:
    s_branch L_back_21
L_slow_24:
    s_mov_b32 s64, 0
L_spin_26:
    buffer_load_dwordx2 v[164:165], v162, s[28:31], s99 offen sc1
    s_waitcnt vmcnt(0)
    v_cmp_ne_u64 vcc, s[44:45], v[164:165]
    s_nop 0
    s_cbranch_vccz L_spun_27
    s_add_u32 s64, s64, 1
    s_cmp_lt_u32 s64, 200000
    s_cbranch_scc1 L_spin_26
L_spun_27:
    s_branch L_back_25
L_slow_28:
    s_mov_b32 s64, 0
L_spin_30:
    buffer_load_dwordx2 v[170:171], v14, s[28:31], s65 offen sc1
    s_waitcnt vmcnt(0)
    v_cmp_ne_u64 vcc, s[44:45], v[170:171]
    s_nop 0
    s_cbranch_vccz L_spun_31
    s_add_u32 s64, s64, 1
    s_cmp_lt_u32 s64, 200000
    s_cbranch_scc1 L_spin_30
L_spun_31:
    s_branch L_back_29
L_code_end:
.section .rodata,"a"
.p2align 6
.amdhsa_kernel parallel_sum__linear_kernel_hedgehog__glu_gated_reglu__prompt_kernel
  .amdhsa_next_free_vgpr 512
  .amdhsa_next_free_sgpr 102
  .amdhsa_accum_offset 256
  .amdhsa_group_segment_fixed_size 0
  .amdhsa_kernarg_size 88
  .amdhsa_user_sgpr_count 2
  .amdhsa_user_sgpr_kernarg_segment_ptr 1
  .amdhsa_system_sgpr_workgroup_id_x 1
  .amdhsa_float_denorm_mode_32 3
.end_amdhsa_kernel
```
